```python
import torch

def _softmax(x, axis=-1):
    return torch.softmax(x, dim=axis)
def _gelu(x):
    return torch.nn.functional.gelu(x, approximate="tanh")
def _silu(x):
    return torch.nn.functional.silu(x)
def _sigmoid(x):
    return torch.sigmoid(x)
def _layernorm(x, axis=-1, eps=1e-5):
    m = x.mean(dim=axis, keepdim=True)
    v = x.var(dim=axis, keepdim=True, unbiased=False)
    return (x - m) / torch.sqrt(v + eps)
def _scatter_add(tgt, idx, src, axis=0):
    return tgt.clone().index_add_(axis, idx, src)
def _segment_sum(src, seg, n):
    out = torch.zeros((n,) + src.shape[1:], dtype=src.dtype)
    return out.index_add_(0, seg, src)
def _pad(x, pw):
    flat = tuple(v for pair in reversed(pw) for v in pair)
    return torch.nn.functional.pad(x, flat)

kernel_name = 'sequential_preLN__linear_kernel_hedgehog__dense_activation_mish__prompt'

def setup_inputs():

    _w = (lambda a: (lambda t: t.to(torch.bfloat16) if t.is_floating_point() else t)(torch.as_tensor(a)))
    def _A_setup():
        B, S, D, H = 1, 2048, 448, 16
        Dh = D // H
        return {
            "x": _w((lambda *s: torch.randn(*s, dtype=torch.bfloat16) * 0.05)(B, S, D)),
            "wqkv": _w((lambda *s: torch.randn(*s, dtype=torch.bfloat16) * 0.2)(D, 3 * D)),
            "w_phi": _w((lambda *s: torch.randn(*s, dtype=torch.bfloat16) * 0.2)(H, Dh, Dh) * (Dh ** -0.5)),
            "wo": _w((lambda *s: torch.randn(*s, dtype=torch.bfloat16) * 0.05)(D, D)),
        }
    _A_in = _A_setup()

    def _B_setup():
        B, S, D, F = 1, 2048, 448, 1792
        return {
            "x": _w((lambda *s: torch.randn(*s, dtype=torch.bfloat16) * 0.05)(B, S, D)),
            "w1": _w((lambda *s: torch.randn(*s, dtype=torch.bfloat16) * 1.6)(D, F) * (D ** -0.5)),
            "b1": _w((lambda *s: torch.randn(*s, dtype=torch.bfloat16) * 0.4)(F)),
            "w2": _w((lambda *s: torch.randn(*s, dtype=torch.bfloat16) * 0.1)(F, D) * (F ** -0.5)),
        }
    _B_in = _B_setup()

    return {
        "A_x": _A_in["x"],
        "A_wqkv": _A_in["wqkv"],
        "A_w_phi": _A_in["w_phi"],
        "A_wo": _A_in["wo"],
        "B_x": _B_in["x"],
        "B_w1": _B_in["w1"],
        "B_b1": _B_in["b1"],
        "B_w2": _B_in["w2"],
    }

def reference(A_x, A_wqkv, A_w_phi, A_wo, B_x, B_w1, B_b1, B_w2):
    def _A_ref(x, wqkv, w_phi, wo):
        B, S, D = x.shape
        H = 16; Dh = D // H
        qkv = (lambda x, *d: x.permute(*d))((x @ wqkv).reshape(B, S, 3, H, Dh), 2, 0, 3, 1, 4)
        q, k, v = qkv[0], qkv[1], qkv[2]
        pq = torch.einsum("bhsd,hdf->bhsf", q, w_phi)
        pk = torch.einsum("bhsd,hdf->bhsf", k, w_phi)
        phi_q = torch.concatenate([_softmax(pq, axis=-1), _softmax(-pq, axis=-1)], axis=-1)
        phi_k = torch.concatenate([_softmax(pk, axis=-1), _softmax(-pk, axis=-1)], axis=-1)
        kv = torch.einsum("bhsf,bhsd->bhfd", phi_k, v)
        z  = torch.einsum("bhsf->bhf", phi_k)
        num = torch.einsum("bhqf,bhfd->bhqd", phi_q, kv)
        den = torch.einsum("bhqf,bhf->bhq", phi_q, z)[..., None] + 1e-6
        o = num / den
        return (lambda x, *d: x.permute(*d))(o, 0, 2, 1, 3).reshape(B, S, D) @ wo

    def _B_ref(x, w1, b1, w2):
        h = torch.einsum("bsd,df->bsf", x, w1) + b1
        sp = torch.log1p(torch.exp(-torch.abs(h))) + torch.where(h > 0, h, torch.zeros_like(h))
        act = h * torch.tanh(sp)
        return torch.einsum("bsf,fd->bsd", act, w2)

    x = A_x
    h = x + _A_ref(_layernorm(x, axis=-1), A_wqkv, A_w_phi, A_wo)
    h2 = h + _B_ref(_layernorm(h, axis=-1), B_w1, B_b1, B_w2)
    return h2
```

```asm
; @launch grid=(256,1,1) block=(512,1,1) lds=163840
.amdgcn_target "amdgcn-amd-amdhsa--gfx950"
.text
.globl sequential_preLN__linear_kernel_hedgehog__dense_activation_mish__prompt_kernel
.p2align 8
.type sequential_preLN__linear_kernel_hedgehog__dense_activation_mish__prompt_kernel,@function
sequential_preLN__linear_kernel_hedgehog__dense_activation_mish__prompt_kernel:
  s_cmp_ge_u32 s2, 256
  s_cbranch_scc1 L_end
  s_load_dwordx2 s[40:41], s[0:1], 0
  s_load_dwordx2 s[44:45], s[0:1], 8
  s_load_dwordx2 s[52:53], s[0:1], 80
  s_load_dwordx2 s[56:57], s[0:1], 16
  s_load_dwordx2 s[60:61], s[0:1], 24
  s_load_dwordx2 s[64:65], s[0:1], 40
  s_load_dwordx2 s[72:73], s[0:1], 48
  s_load_dwordx2 s[68:69], s[0:1], 56
  s_load_dwordx2 s[76:77], s[0:1], 64
  s_lshr_b32 s5, s2, 3
  s_getpc_b64 s[96:97]
L_pc:
  v_lshrrev_b32 v5, 6, v0
  v_lshl_add_u32 v6, s5, 3, v5
  v_readfirstlane_b32 s3, v5
  v_lshlrev_b32 v6, 7, v6
  v_min_u32 v6, L_code_end-L_pc-4, v6
  global_load_dword v240, v6, s[96:97]
  s_lshl_b32 s24, s5, 3
  s_add_u32 s24, s24, s3
  s_lshl_b32 s24, s24, 7
  s_add_u32 s24, s24, L_table-L_pc
  s_add_u32 s96, s96, s24
  s_addc_u32 s97, s97, 0
  v_and_b32 v1, 63, v0
  s_and_b32 s4, s2, 7
  s_lshr_b32 s6, s5, 4
  s_add_u32 s28, s5, s4
  s_bfe_u32 s27, s5, 0x10003
  s_lshl_b32 s27, s27, 1
  s_add_u32 s28, s28, s27
  s_mul_i32 s27, s28, 37
  s_lshr_b32 s27, s27, 8
  s_mul_i32 s27, s27, 7
  s_sub_u32 s27, s28, s27
  v_lshrrev_b32 v6, 3, v1
  v_lshrrev_b32 v7, 4, v1
  v_and_b32 v8, 7, v1
  v_xor_b32 v8, v8, v7
  v_lshlrev_b32 v8, 4, v8
  v_mul_u32_u24 v2, 896, v6
  v_add_u32 v2, v2, v8
  v_xor_b32 v3, 64, v2
  v_add_u32 v3, 6144, v3
  v_lshrrev_b32 v8, 2, v1
  v_xor_b32 v8, v8, v7
  v_and_b32 v8, 1, v8
  v_and_b32 v9, 3, v1
  v_lshlrev_b32 v9, 4, v9
  v_mad_u32_u24 v9, v8, 56, v9
  v_mul_u32_u24 v4, 2688, v6
  v_add_u32 v4, v4, v9
  v_lshlrev_b32 v15, 4, v1
  v_cmp_gt_u32 vcc, 56, v1
  v_mov_b32 v201, 2130706432
  s_nop 0
  v_cndmask_b32 v10, v201, v15, vcc
  s_lshl_b32 s24, s4, 8
  s_and_b32 s25, s5, 8
  s_lshl_b32 s25, s25, 4
  s_add_u32 s24, s24, s25
  s_and_b32 s30, s5, 7
  s_lshl_b32 s25, s6, 3
  s_add_u32 s25, s25, s30
  s_lshl_b32 s25, s25, 3
  s_add_u32 s25, s25, s3
  s_add_u32 s32, s24, s25
  s_mul_i32 s32, s32, 896
  s_lshl_b32 s25, s3, 4
  s_add_u32 s24, s24, s25
  s_mul_i32 s24, s24, 896
  s_mul_i32 s26, s3, 21504
  s_mul_i32 s25, s30, 112
  s_add_u32 s26, s26, s25
  s_mul_i32 s25, s6, 896
  s_add_u32 s25, s25, s26
  s_add_u32 s25, s25, 896
  s_lshl_b32 s28, s3, 11
  s_lshl_b32 s29, s3, 10
  s_add_u32 s29, s29, 114688
  s_mov_b32 s42, 1835008
  s_mov_b32 s43, 0x20000
  s_mov_b32 s46, 1204224
  s_mov_b32 s47, 0x20000
  s_waitcnt lgkmcnt(0)
  s_load_dwordx2 s[38:39], s[52:53], 0
  s_load_dwordx16 s[8:23], s[96:97], 0
  s_load_dwordx16 s[80:95], s[96:97], 64
  buffer_load_dwordx4 v[16:19], v10, s[40:43], s32 offen
  s_lshl_b32 s37, s27, 7
  s_add_u32 s37, s37, s24
  s_add_u32 m0, s28, 0
  s_nop 0
  buffer_load_dwordx4 v2, s[40:43], s37 offen lds
  buffer_load_dwordx4 v3, s[40:43], s37 offen offset:1024 lds
  s_mul_i32 s37, s27, 172032
  s_add_u32 s37, s37, s25
  s_add_u32 m0, s29, 0
  s_nop 0
  buffer_load_dwordx4 v4, s[44:47], s37 offen lds
  s_add_u32 s27, s27, 1
  s_cmp_eq_u32 s27, 7
  s_cselect_b32 s27, 0, s27
  s_barrier
  s_lshl_b32 s37, s27, 7
  s_add_u32 s37, s37, s24
  s_add_u32 m0, s28, 16384
  s_nop 0
  buffer_load_dwordx4 v2, s[40:43], s37 offen lds
  buffer_load_dwordx4 v3, s[40:43], s37 offen offset:1024 lds
  s_and_b32 s7, s3, 3
  s_mul_i32 s32, s30, 3136
  s_lshr_b32 s30, s3, 2
  v_and_b32 v192, 31, v1
  v_lshrrev_b32 v193, 5, v1
  v_bfe_u32 v194, v1, 2, 2
  v_bfe_u32 v195, v1, 4, 1
  v_and_b32 v196, 3, v1
  v_lshlrev_b32 v196, 3, v196
  v_bfe_u32 v197, v1, 3, 1
  v_lshl_add_u32 v198, v195, 5, v196
  s_lshl_b32 s37, s7, 12
  s_lshl_b32 s36, s7, 5
  v_bfe_u32 v12, v192, 1, 3
  v_xor_b32 v12, v12, v193
  v_lshlrev_b32 v12, 4, v12
  v_xor_b32 v12, s36, v12
  v_lshl_add_u32 v6, v192, 7, v12
  v_add_u32 v6, s37, v6
  v_xor_b32 v7, 32, v6
  v_cmp_eq_u32 vcc, 0, v8
  v_xor_b32 v8, 64, v6
  v_xor_b32 v9, 96, v6
  v_lshl_add_u32 v12, v193, 3, v194
  v_lshl_add_u32 v10, v12, 7, v198
  s_lshl_b32 s37, s7, 11
  s_add_u32 s37, s37, 114688
  v_xor_b32 v12, s30, v197
  v_lshl_add_u32 v10, v12, 6, v10
  v_add_u32 v10, s37, v10
  v_xor_b32 v11, 0x800, v10
  v_xor_b32 v12, 0x1000, v10
  v_xor_b32 v0, 0x1800, v10
  v_mov_b32 v14, 0x3f803f80
  v_cndmask_b32 v241, 0, v14, vcc
  v_cndmask_b32 v242, 0, v14, vcc
  v_cndmask_b32 v243, 0, v14, vcc
  s_mov_b32 s58, 25088
  s_mov_b32 s59, 0x20000
  s_lshl_b32 s37, s4, 21
  s_add_u32 s37, s37, 4194304
  s_add_u32 s48, s52, s37
  s_addc_u32 s49, s53, 0
  s_mov_b32 s50, 0x200000
  s_mov_b32 s51, 0x20000
  s_mov_b32 s54, 0x400000
  s_mov_b32 s55, 0x20000
  s_waitcnt lgkmcnt(0)
  s_mov_b32 s62, 401408
  s_mov_b32 s63, 0x20000
  s_mov_b32 s66, 1605632
  s_mov_b32 s67, 0x20000
  s_mov_b32 s70, 1605632
  s_mov_b32 s71, 0x20000
  s_mov_b32 s74, 3584
  s_mov_b32 s75, 0x20000
  s_mov_b32 s78, 1835008
  s_mov_b32 s79, 0x20000
  s_mov_b32 s101, 40000
  v_lshlrev_b32 v13, 4, v192
  v_lshlrev_b32 v199, 7, v1
  v_add_u32 v237, s94, v199
  v_cmp_gt_u32 vcc, 21, v1
  s_nop 1
  v_cndmask_b32 v237, v201, v237, vcc
  v_add_u32 v200, s12, v199
  v_cmp_gt_u32 vcc, 16, v1
  s_nop 1
  v_cndmask_b32 v237, v237, v200, vcc
  v_add_u32 v200, s93, v199
  v_lshrrev_b32 v199, 4, v1
  v_cmp_eq_u32 vcc, 2, v199
  s_nop 1
  v_cndmask_b32 v237, v237, v200, vcc
  v_lshl_add_u32 v199, v193, 2, v194
  s_mul_i32 s37, s30, 1568
  s_add_u32 s37, s37, 155648
  v_mad_u32_u24 v224, v199, 56, v198
  v_add_u32 v224, s37, v224
  v_lshl_add_u32 v233, v199, 7, v198
  v_lshl_add_u32 v233, v197, 6, v233
  v_lshrrev_b32 v199, 3, v1
  v_and_b32 v200, 7, v1
  v_lshlrev_b32 v229, 4, v200
  v_lshl_add_u32 v229, v199, 10, v229
  v_lshlrev_b32 v232, 2, v195
  v_xor_b32 v200, v200, v232
  v_lshlrev_b32 v200, 4, v200
  v_mul_u32_u24 v230, 896, v199
  v_add_u32 v230, v230, v200
  v_mul_u32_u24 v231, 3584, v199
  v_add_u32 v231, v231, v200
  v_mul_u32_u24 v232, 896, v192
  v_lshl_add_u32 v232, v193, 4, v232
  s_lshl_b32 s37, s30, 10
  s_add_u32 s37, s37, 159744
  v_add_u32 v235, s37, v15
  s_lshl_b32 s37, s7, 2
  v_add_u32 v198, s37, v235
  s_lshl_b32 s37, s4, 11
  s_add_u32 s13, s13, s37
  s_add_u32 s15, s15, s37
  s_lshl_b32 s37, s4, 15
  s_add_u32 s14, s14, s37
  s_add_u32 s34, s14, 0x2000
  s_mul_i32 s37, s4, 229376
  s_add_u32 s22, s22, s37
  s_mul_i32 s35, s3, 7168
  s_and_b32 s37, s5, 0x13
  s_cmp_eq_u32 s37, 3
  s_cselect_b32 s36, 1, 0
  s_mul_i32 s37, s36, s4
  s_lshl_b32 s37, s37, 9
  s_add_u32 s20, s20, s37
  s_lshl_b32 s37, s37, 2
  s_add_u32 s92, s92, s37
  s_cmp_lg_u32 s6, 0
  s_cbranch_scc1 Lcb_1
  s_lshl_b32 s96, s30, 7
  s_lshl_b32 s37, s7, 5
  s_add_u32 s97, s37, s96
  v_add_u32 v199, s97, v192
  v_bfe_u32 v200, v199, 3, 1
  v_lshlrev_b32 v200, 4, v200
  v_bfe_u32 v225, v199, 1, 2
  v_lshl_or_b32 v225, v225, 5, v200
  v_and_b32 v226, 1, v199
  v_lshl_or_b32 v225, v226, 3, v225
  v_bfe_u32 v226, v199, 2, 1
  v_lshl_or_b32 v200, v226, 5, v200
  v_bfe_u32 v226, v199, 1, 1
  v_lshl_or_b32 v226, v226, 3, v200
  v_lshl_or_b32 v225, v199, 7, v225
  v_lshl_or_b32 v226, v199, 6, v226
  v_lshlrev_b32 v200, 3, v193
  v_xor_b32 v225, v225, v200
  v_xor_b32 v226, v226, v200
  v_add_u32 v225, 114688, v225
  v_add_u32 v226, 147456, v226
  v_lshrrev_b32 v199, 2, v1
  v_add_u32 v199, s96, v199
  v_bfe_u32 v200, v199, 3, 1
  v_lshlrev_b32 v200, 4, v200
  v_bfe_u32 v227, v199, 1, 2
  v_lshl_or_b32 v227, v227, 5, v200
  v_and_b32 v228, 1, v199
  v_lshl_or_b32 v227, v228, 3, v227
  v_bfe_u32 v228, v199, 2, 1
  v_lshl_or_b32 v200, v228, 5, v200
  v_bfe_u32 v228, v199, 1, 1
  v_lshl_or_b32 v228, v228, 3, v200
  v_lshl_or_b32 v227, v199, 7, v227
  v_lshl_or_b32 v228, v199, 6, v228
  v_xor_b32 v227, v227, v196
  v_xor_b32 v227, s37, v227
  v_xor_b32 v228, v228, v196
  v_add_u32 v227, 114688, v227
  v_add_u32 v228, 147456, v228
  v_xor_b32 v202, 32, v228
  v_add_u32 v234, 0x4000, v15
  s_branch Lcj_2
Lcb_1:
  v_and_b32 v199, 15, v1
  v_lshl_add_u32 v199, v195, 5, v199
  v_lshlrev_b32 v199, 4, v199
  v_lshl_add_u32 v199, v193, 3, v199
  s_lshl_b32 s37, s3, 10
  s_add_u32 s37, s37, 155648
  v_add_u32 v234, s37, v199
  s_lshl_b32 s37, s30, 12
  s_add_u32 s37, s37, 155648
  v_add_u32 v227, s37, v15
  s_lshl_b32 s37, s4, 17
  s_add_u32 s16, s16, s37
Lcj_2:
  s_mul_i32 s37, s27, 172032
  s_add_u32 s37, s37, s25
  s_add_u32 m0, s29, 8192
  s_nop 0
  buffer_load_dwordx4 v4, s[44:47], s37 offen lds
  s_add_u32 s27, s27, 1
  s_cmp_eq_u32 s27, 7
  s_cselect_b32 s27, 0, s27
  s_waitcnt vmcnt(6)
  v_mov_b32 v240, v241
  s_add_u32 s38, s38, 1
  s_addc_u32 s39, s39, 0
  v_mov_b32 v250, s38
  v_mov_b32 v251, s39
  s_getreg_b32 s31, hwreg(HW_REG_XCC_ID, 0, 4)
  v_mov_b32 v252, s31
  v_mov_b32 v253, 0
  v_mov_b32 v20, 0
  v_mov_b32 v21, 0
  v_dot2c_f32_bf16 v20, v16, v14
  v_dot2c_f32_bf16 v21, v16, v16
  v_dot2c_f32_bf16 v20, v17, v14
  v_dot2c_f32_bf16 v21, v17, v17
  v_dot2c_f32_bf16 v20, v18, v14
  v_dot2c_f32_bf16 v21, v18, v18
  v_dot2c_f32_bf16 v20, v19, v14
  v_dot2c_f32_bf16 v21, v19, v19
  s_lshl_b32 s33, s4, 9
  s_add_u32 s10, s10, s33
  s_add_u32 s33, s33, 4096
  v_add_f32_dpp v20, v20, v20 row_ror:8 row_mask:0xf bank_mask:0xf
  v_add_f32_dpp v21, v21, v21 row_ror:8 row_mask:0xf bank_mask:0xf
  s_nop 0
  v_add_f32_dpp v20, v20, v20 row_ror:4 row_mask:0xf bank_mask:0xf
  v_add_f32_dpp v21, v21, v21 row_ror:4 row_mask:0xf bank_mask:0xf
  s_nop 0
  v_add_f32_dpp v20, v20, v20 row_ror:2 row_mask:0xf bank_mask:0xf
  v_add_f32_dpp v21, v21, v21 row_ror:2 row_mask:0xf bank_mask:0xf
  s_nop 0
  v_add_f32_dpp v20, v20, v20 row_ror:1 row_mask:0xf bank_mask:0xf
  v_add_f32_dpp v21, v21, v21 row_ror:1 row_mask:0xf bank_mask:0xf
  v_mov_b32 v16, v20
  v_mov_b32 v17, v21
  s_nop 0
  v_permlane16_swap_b32 v16, v20
  v_permlane16_swap_b32 v17, v21
  v_add_f32 v20, v16, v20
  v_add_f32 v21, v17, v21
  v_mov_b32 v16, v20
  v_mov_b32 v17, v21
  s_nop 0
  v_permlane32_swap_b32 v16, v20
  v_permlane32_swap_b32 v17, v21
  v_add_f32 v20, v16, v20
  v_add_f32 v21, v17, v21
  v_mul_f32 v20, 0xbb124925, v20
  v_mul_f32 v21, 0x3b124925, v21
  v_fma_f32 v21, -v20, v20, v21
  v_max_f32 v21, 0, v21
  v_add_f32 v21, 0x3727c5ac, v21
  v_rsq_f32 v21, v21
  v_mov_b32 v22, v250
  v_mov_b32 v23, v251
  s_mov_b64 exec, 1
  buffer_store_dwordx4 v[20:23], v253, s[48:51], s8 offen sc1
  s_cmp_lg_u32 s3, 0
  s_cbranch_scc1 Ltab_3
  buffer_store_dwordx4 v[250:253], v253, s[52:55], s10 offen sc1
Ltab_3:
  s_mov_b64 exec, -1
  s_waitcnt vmcnt(4) lgkmcnt(0)
  s_barrier
  ds_read_b64_tr_b16 v[144:145], v10 offset:0
  ds_read_b64_tr_b16 v[146:147], v10 offset:512
  ds_read_b128 v[32:35], v6 offset:0
  s_lshl_b32 s37, s27, 7
  s_add_u32 s37, s37, s24
  s_add_u32 m0, s28, 32768
  s_nop 0
  buffer_load_dwordx4 v2, s[40:43], s37 offen lds
  ds_read_b64_tr_b16 v[148:149], v11 offset:0
  ds_read_b64_tr_b16 v[150:151], v11 offset:512
  ds_read_b128 v[36:39], v7 offset:0
  buffer_load_dwordx4 v3, s[40:43], s37 offen offset:1024 lds
  ds_read_b64_tr_b16 v[152:153], v12 offset:0
  ds_read_b64_tr_b16 v[154:155], v12 offset:512
  ds_read_b128 v[40:43], v8 offset:0
  s_mul_i32 s37, s27, 172032
  s_add_u32 s37, s37, s25
  s_add_u32 m0, s29, 16384
  s_nop 0
  buffer_load_dwordx4 v4, s[44:47], s37 offen lds
  s_add_u32 s27, s27, 1
  s_cmp_eq_u32 s27, 7
  s_cselect_b32 s27, 0, s27
  ds_read_b64_tr_b16 v[156:157], v0 offset:0
  ds_read_b64_tr_b16 v[158:159], v0 offset:512
  ds_read_b128 v[44:47], v9 offset:0
  s_lshl_b32 s37, s7, 10
  s_add_u32 m0, s37, 155648
  s_add_u32 s37, s37, s32
  buffer_load_dwordx4 v15, s[56:59], s37 offen lds
  s_lshl_b32 s32, s3, 10
  s_waitcnt vmcnt(5) lgkmcnt(0)
  v_mfma_f32_32x32x16_bf16 v[16:31], v[144:147], v[32:35], 0
  s_barrier
  v_mfma_f32_16x16x32_bf16 v[208:211], v[240:243], v[144:147], 0
  ds_read_b64_tr_b16 v[160:161], v10 offset:8192
  ds_read_b64_tr_b16 v[162:163], v10 offset:8704
  ds_read_b128 v[48:51], v6 offset:16384
  s_lshl_b32 s37, s27, 7
  s_add_u32 s37, s37, s24
  s_add_u32 m0, s28, 49152
  s_nop 0
  buffer_load_dwordx4 v2, s[40:43], s37 offen lds
  v_mfma_f32_32x32x16_bf16 v[16:31], v[148:151], v[36:39], v[16:31]
  ds_read_b64_tr_b16 v[164:165], v11 offset:8192
  ds_read_b64_tr_b16 v[166:167], v11 offset:8704
  ds_read_b128 v[52:55], v7 offset:16384
  buffer_load_dwordx4 v3, s[40:43], s37 offen offset:1024 lds
  v_mfma_f32_32x32x16_bf16 v[16:31], v[152:155], v[40:43], v[16:31]
  ds_read_b64_tr_b16 v[168:169], v12 offset:8192
  ds_read_b64_tr_b16 v[170:171], v12 offset:8704
  ds_read_b128 v[56:59], v8 offset:16384
  s_mul_i32 s37, s27, 172032
  s_add_u32 s37, s37, s25
  s_add_u32 m0, s29, 24576
  s_nop 0
  buffer_load_dwordx4 v4, s[44:47], s37 offen lds
  s_add_u32 s27, s27, 1
  s_cmp_eq_u32 s27, 7
  s_cselect_b32 s27, 0, s27
  v_mfma_f32_32x32x16_bf16 v[16:31], v[156:159], v[44:47], v[16:31]
  ds_read_b64_tr_b16 v[172:173], v0 offset:8192
  ds_read_b64_tr_b16 v[174:175], v0 offset:8704
  ds_read_b128 v[60:63], v9 offset:16384
  s_waitcnt vmcnt(4) lgkmcnt(0)
  v_mfma_f32_32x32x16_bf16 v[16:31], v[160:163], v[48:51], v[16:31]
  s_barrier
  v_mfma_f32_16x16x32_bf16 v[208:211], v[240:243], v[160:163], v[208:211]
  ds_read_b64_tr_b16 v[144:145], v10 offset:16384
  ds_read_b64_tr_b16 v[146:147], v10 offset:16896
  ds_read_b128 v[64:67], v6 offset:32768
  s_lshl_b32 s37, s27, 7
  s_add_u32 s37, s37, s24
  s_add_u32 m0, s28, 65536
  s_nop 0
  buffer_load_dwordx4 v2, s[40:43], s37 offen lds
  v_mfma_f32_32x32x16_bf16 v[16:31], v[164:167], v[52:55], v[16:31]
  ds_read_b64_tr_b16 v[148:149], v11 offset:16384
  ds_read_b64_tr_b16 v[150:151], v11 offset:16896
  ds_read_b128 v[68:71], v7 offset:32768
  buffer_load_dwordx4 v3, s[40:43], s37 offen offset:1024 lds
  v_mfma_f32_32x32x16_bf16 v[16:31], v[168:171], v[56:59], v[16:31]
  ds_read_b64_tr_b16 v[152:153], v12 offset:16384
  ds_read_b64_tr_b16 v[154:155], v12 offset:16896
  ds_read_b128 v[72:75], v8 offset:32768
  s_mul_i32 s37, s27, 172032
  s_add_u32 s37, s37, s25
  s_add_u32 m0, s29, 32768
  s_nop 0
  buffer_load_dwordx4 v4, s[44:47], s37 offen lds
  s_add_u32 s27, s27, 1
  s_cmp_eq_u32 s27, 7
  s_cselect_b32 s27, 0, s27
  v_mfma_f32_32x32x16_bf16 v[16:31], v[172:175], v[60:63], v[16:31]
  ds_read_b64_tr_b16 v[156:157], v0 offset:16384
  ds_read_b64_tr_b16 v[158:159], v0 offset:16896
  ds_read_b128 v[76:79], v9 offset:32768
  v_lshlrev_b32 v238, 7, v1
  v_cmp_gt_u32 vcc, 7, v1
  s_lshl_b32 s37, s2, 2
  s_add_u32 s37, s37, s7
  v_cndmask_b32 v238, v201, v238, vcc
  s_cmp_ge_u32 s3, 4
  s_cbranch_scc1 Lma_4
  s_mul_i32 s37, s37, 2688
  buffer_load_dword v239, v238, s[44:47], s37 offen
  s_branch Lmb_5
Lma_4:
  s_mul_i32 s37, s37, 896
  buffer_load_dword v239, v238, s[60:63], s37 offen
Lmb_5:
  v_lshlrev_b32 v238, 7, v1
  v_cmp_gt_u32 vcc, 13, v1
  s_lshl_b32 s37, s2, 2
  s_add_u32 s37, s37, s7
  v_cndmask_b32 v238, v201, v238, vcc
  s_cmp_ge_u32 s3, 4
  s_cbranch_scc1 Lma_6
  s_mul_i32 s37, s37, 1664
  buffer_load_dword v239, v238, s[64:67], s37 offen
  s_branch Lmb_7
Lma_6:
  s_mul_i32 s37, s37, 1664
  buffer_load_dword v239, v238, s[68:71], s37 offen
Lmb_7:
  s_cmp_lg_u32 s6, 0
  s_cbranch_scc1 L_roleB
  s_waitcnt vmcnt(5) lgkmcnt(0)
  v_mfma_f32_32x32x16_bf16 v[16:31], v[144:147], v[64:67], v[16:31]
  s_barrier
  v_mfma_f32_16x16x32_bf16 v[208:211], v[240:243], v[144:147], v[208:211]
  ds_read_b64_tr_b16 v[160:161], v10 offset:24576
  ds_read_b64_tr_b16 v[162:163], v10 offset:25088
  ds_read_b128 v[80:83], v6 offset:49152
  buffer_load_dwordx4 v[176:179], v13, s[48:51], s9 offen sc1
  buffer_load_dwordx4 v[180:183], v13, s[52:55], s33 offen sc1
  buffer_load_dword v239, v253, s[48:51], s11 offen sc1
  v_mfma_f32_32x32x16_bf16 v[16:31], v[148:151], v[68:71], v[16:31]
  ds_read_b64_tr_b16 v[164:165], v11 offset:24576
  ds_read_b64_tr_b16 v[166:167], v11 offset:25088
  ds_read_b128 v[84:87], v7 offset:49152
  s_lshl_b32 s37, s27, 7
  s_add_u32 s37, s37, s24
  s_add_u32 m0, s28, 81920
  s_nop 0
  buffer_load_dwordx4 v2, s[40:43], s37 offen lds
  v_mfma_f32_32x32x16_bf16 v[16:31], v[152:155], v[72:75], v[16:31]
  ds_read_b64_tr_b16 v[168:169], v12 offset:24576
  ds_read_b64_tr_b16 v[170:171], v12 offset:25088
  ds_read_b128 v[88:91], v8 offset:49152
  buffer_load_dwordx4 v3, s[40:43], s37 offen offset:1024 lds
  v_mfma_f32_32x32x16_bf16 v[16:31], v[156:159], v[76:79], v[16:31]
  ds_read_b64_tr_b16 v[172:173], v0 offset:24576
  ds_read_b64_tr_b16 v[174:175], v0 offset:25088
  ds_read_b128 v[92:95], v9 offset:49152
  s_mul_i32 s37, s27, 172032
  s_add_u32 s37, s37, s25
  s_add_u32 m0, s29, 0
  s_nop 0
  buffer_load_dwordx4 v4, s[44:47], s37 offen lds
  s_add_u32 s27, s27, 1
  s_cmp_eq_u32 s27, 7
  s_cselect_b32 s27, 0, s27
  s_waitcnt vmcnt(8) lgkmcnt(0)
  v_add_u32 v6, 0x10000, v6
  v_add_u32 v7, 0x10000, v7
  v_add_u32 v8, 0x10000, v8
  v_add_u32 v9, 0x10000, v9
  v_mfma_f32_32x32x16_bf16 v[16:31], v[160:163], v[80:83], v[16:31]
  s_barrier
  v_mfma_f32_16x16x32_bf16 v[208:211], v[240:243], v[160:163], v[208:211]
  ds_read_b64_tr_b16 v[144:145], v10 offset:32768
  ds_read_b64_tr_b16 v[146:147], v10 offset:33280
  ds_read_b128 v[96:99], v6 offset:0
  s_lshl_b32 s37, s27, 7
  s_add_u32 s37, s37, s24
  s_add_u32 m0, s28, 98304
  s_nop 0
  buffer_load_dwordx4 v2, s[40:43], s37 offen lds
  v_mfma_f32_32x32x16_bf16 v[16:31], v[164:167], v[84:87], v[16:31]
  ds_read_b64_tr_b16 v[148:149], v11 offset:32768
  ds_read_b64_tr_b16 v[150:151], v11 offset:33280
  ds_read_b128 v[100:103], v7 offset:0
  buffer_load_dwordx4 v3, s[40:43], s37 offen offset:1024 lds
  v_mfma_f32_32x32x16_bf16 v[16:31], v[168:171], v[88:91], v[16:31]
  ds_read_b64_tr_b16 v[152:153], v12 offset:32768
  ds_read_b64_tr_b16 v[154:155], v12 offset:33280
  ds_read_b128 v[104:107], v8 offset:0
  s_mul_i32 s37, s27, 172032
  s_add_u32 s37, s37, s25
  s_add_u32 m0, s29, 8192
  s_nop 0
  buffer_load_dwordx4 v4, s[44:47], s37 offen lds
  s_add_u32 s27, s27, 1
  s_cmp_eq_u32 s27, 7
  s_cselect_b32 s27, 0, s27
  v_mfma_f32_32x32x16_bf16 v[16:31], v[172:175], v[92:95], v[16:31]
  ds_read_b64_tr_b16 v[156:157], v0 offset:32768
  ds_read_b64_tr_b16 v[158:159], v0 offset:33280
  ds_read_b128 v[108:111], v9 offset:0
  s_waitcnt lgkmcnt(8)
  ds_read_b64_tr_b16 v[216:217], v224 offset:0
  ds_read_b64_tr_b16 v[218:219], v224 offset:448
  ds_read_b64_tr_b16 v[220:221], v224 offset:896
  ds_read_b64_tr_b16 v[222:223], v224 offset:1344
  s_waitcnt vmcnt(3) lgkmcnt(0)
  v_mfma_f32_32x32x16_bf16 v[16:31], v[144:147], v[96:99], v[16:31]
  s_barrier
  v_mfma_f32_16x16x32_bf16 v[208:211], v[240:243], v[144:147], v[208:211]
  ds_read_b64_tr_b16 v[160:161], v10 offset:0
  ds_read_b64_tr_b16 v[162:163], v10 offset:512
  ds_read_b128 v[112:115], v6 offset:16384
  s_add_u32 m0, s32, 0
  s_add_u32 s37, s20, 0
  buffer_load_dwordx4 v231, s[64:67], s37 offen lds
  v_mfma_f32_32x32x16_bf16 v[16:31], v[148:151], v[100:103], v[16:31]
  ds_read_b64_tr_b16 v[164:165], v11 offset:0
  ds_read_b64_tr_b16 v[166:167], v11 offset:512
  ds_read_b128 v[116:119], v7 offset:16384
  s_add_u32 m0, s32, 8192
  s_add_u32 s37, s20, 229376
  buffer_load_dwordx4 v231, s[64:67], s37 offen lds
  v_mfma_f32_32x32x16_bf16 v[16:31], v[152:155], v[104:107], v[16:31]
  ds_read_b64_tr_b16 v[168:169], v12 offset:0
  ds_read_b64_tr_b16 v[170:171], v12 offset:512
  ds_read_b128 v[120:123], v8 offset:16384
  s_add_u32 m0, s32, 16384
  s_add_u32 s37, s20, 458752
  buffer_load_dwordx4 v231, s[64:67], s37 offen lds
  v_mfma_f32_32x32x16_bf16 v[16:31], v[156:159], v[108:111], v[16:31]
  ds_read_b64_tr_b16 v[172:173], v0 offset:0
  ds_read_b64_tr_b16 v[174:175], v0 offset:512
  ds_read_b128 v[124:127], v9 offset:16384
  s_add_u32 m0, s32, 24576
  s_add_u32 s37, s20, 688128
  buffer_load_dwordx4 v231, s[64:67], s37 offen lds
  ds_write_b32 v198, v208
  s_mov_b32 exec_lo, 0
  v_mov_b32 v222, 0
  v_mov_b32 v223, 0
  s_mov_b32 exec_lo, -1
  s_branch Lpc_10
Lpt_8:
  buffer_load_dwordx4 v[176:179], v13, s[48:51], s9 offen sc1
  buffer_load_dwordx4 v[180:183], v13, s[52:55], s33 offen sc1
  s_waitcnt vmcnt(0)
Lpc_10:
  v_cmp_ne_u64 vcc, s[38:39], v[178:179]
  v_cmp_ne_u64 s[96:97], s[38:39], v[180:181]
  s_nop 0
  s_or_b64 vcc, s[96:97], vcc
  s_cbranch_scc0 Lpd_9
  s_sub_u32 s101, s101, 1
  s_cbranch_scc1 Lpd_9
  s_sleep 1
  s_branch Lpt_8
Lpd_9:
  v_cmp_ne_u32 vcc, s31, v182
  v_cvt_pk_bf16_f32 v184, v176, v176
  v_lshlrev_b32 v212, 16, v184
  v_sub_f32 v212, v176, v212
  v_cvt_pk_bf16_f32 v185, v212, v212
  s_or_b32 s100, vcc_lo, vcc_hi
  v_mul_f32 v5, 1069066811, v177
  v_mov_b32 v178, v177
  v_mov_b32 v186, 0
  v_mov_b32 v187, 0
  v_mov_b32 v190, 0
  v_mov_b32 v191, 0
  s_mov_b32 exec_lo, 0
  v_mov_b32 v184, 0
  v_mov_b32 v185, 0
  s_mov_b32 exec_lo, -1
  s_waitcnt vmcnt(4) lgkmcnt(0)
  v_mfma_f32_32x32x16_bf16 v[16:31], v[160:163], v[112:115], v[16:31]
  s_barrier
  v_mfma_f32_16x16x32_bf16 v[208:211], v[240:243], v[160:163], 0
  ds_read_b64_tr_b16 v[144:145], v10 offset:8192
  ds_read_b64_tr_b16 v[146:147], v10 offset:8704
  ds_read_b128 v[128:131], v6 offset:32768
  s_add_u32 m0, s32, 32768
  s_add_u32 s37, s20, 917504
  buffer_load_dwordx4 v231, s[64:67], s37 offen lds
  v_mfma_f32_32x32x16_bf16 v[16:31], v[164:167], v[116:119], v[16:31]
  v_mfma_f32_16x16x32_bf16 v[208:211], v[240:243], v[164:167], v[208:211]
  ds_read_b64_tr_b16 v[148:149], v11 offset:8192
  ds_read_b64_tr_b16 v[150:151], v11 offset:8704
  ds_read_b128 v[132:135], v7 offset:32768
  s_add_u32 m0, s32, 40960
  s_add_u32 s37, s20, 1146880
  buffer_load_dwordx4 v231, s[64:67], s37 offen lds
  v_mfma_f32_32x32x16_bf16 v[16:31], v[168:171], v[120:123], v[16:31]
  v_mfma_f32_16x16x32_bf16 v[208:211], v[240:243], v[168:171], v[208:211]
  ds_read_b64_tr_b16 v[152:153], v12 offset:8192
  ds_read_b64_tr_b16 v[154:155], v12 offset:8704
  ds_read_b128 v[136:139], v8 offset:32768
  s_add_u32 m0, s32, 49152
  s_add_u32 s37, s20, 1376256
  buffer_load_dwordx4 v231, s[64:67], s37 offen lds
  v_mfma_f32_32x32x16_bf16 v[16:31], v[172:175], v[124:127], v[16:31]
  v_mfma_f32_16x16x32_bf16 v[208:211], v[240:243], v[172:175], v[208:211]
  ds_read_b64_tr_b16 v[156:157], v0 offset:8192
  ds_read_b64_tr_b16 v[158:159], v0 offset:8704
  ds_read_b128 v[140:143], v9 offset:32768
  ds_read_b128 v[204:207], v235
  v_xor_b32 v106, 16, v225
  v_xor_b32 v107, 32, v225
  v_xor_b32 v108, 48, v225
  v_xor_b32 v109, 64, v225
  v_xor_b32 v110, 80, v225
  v_xor_b32 v111, 96, v225
  v_xor_b32 v112, 112, v225
  v_xor_b32 v113, 16, v226
  v_xor_b32 v114, 32, v226
  v_xor_b32 v115, 48, v226
  s_waitcnt lgkmcnt(0)
  v_mfma_f32_16x16x32_bf16 v[208:211], v[240:243], v[144:147], v[208:211]
  v_mfma_f32_16x16x32_bf16 v[208:211], v[240:243], v[148:151], v[208:211]
  v_mfma_f32_16x16x32_bf16 v[208:211], v[240:243], v[152:155], v[208:211]
  v_mfma_f32_16x16x32_bf16 v[208:211], v[240:243], v[156:159], v[208:211]
  s_barrier
  v_mfma_f32_32x32x16_bf16 v[16:31], v[144:147], v[128:131], v[16:31]
  v_add_f32 v204, v204, v205
  v_add_f32 v206, v206, v207
  v_add_f32 v204, v204, v206
  v_mfma_f32_32x32x16_bf16 v[16:31], v[148:151], v[132:135], v[16:31]
  v_mfma_f32_32x32x16_bf16 v[16:31], v[152:155], v[136:139], v[16:31]
  s_nop 0
  v_add_f32 v208, v208, v204
  v_cvt_pk_bf16_f32 v212, v208, v208
  v_lshlrev_b32 v212, 16, v212
  v_sub_f32 v212, v208, v212
  v_cvt_pk_bf16_f32 v188, v208, v212
  v_mov_b32 v189, v188
  v_mfma_f32_32x32x16_bf16 v[16:31], v[156:159], v[140:143], v[16:31]
  s_nop 0
  v_mfma_f32_32x32x16_bf16 v[16:31], v[188:191], v[184:187], v[16:31]
  s_nop 11
  v_cvt_pk_bf16_f32 v32, v16, v17
  v_cvt_pk_bf16_f32 v33, v18, v19
  v_cvt_pk_bf16_f32 v34, v20, v21
  v_cvt_pk_bf16_f32 v35, v22, v23
  v_cvt_pk_bf16_f32 v36, v24, v25
  v_cvt_pk_bf16_f32 v37, v26, v27
  v_cvt_pk_bf16_f32 v38, v28, v29
  v_cvt_pk_bf16_f32 v39, v30, v31
  v_mfma_f32_32x32x16_bf16 v[16:31], v[216:219], v[32:35], 0
  s_nop 0
  v_mfma_f32_32x32x16_bf16 v[16:31], v[220:223], v[36:39], v[16:31]
  v_mov_b32 v122, v5
  v_mov_b32 v128, 0
  v_mov_b32 v129, 0
  v_mov_b32 v130, 0
  v_mov_b32 v131, 0
  v_and_b32 v237, 0x70, v229
  v_lshrrev_b32 v132, 3, v1
  v_lshl_add_u32 v237, v132, 17, v237
  buffer_store_dwordx4 v[128:131], v15, s[52:55], s13 offen sc1
  buffer_store_dwordx4 v[128:131], v234, s[52:55], s13 offen sc1
  buffer_store_dwordx4 v[128:131], v237, s[52:55], s15 offen sc1
  s_mov_b32 exec_lo, 0
  v_mov_b32 v28, v16
  v_mov_b32 v29, v16
  v_mov_b32 v30, v16
  v_mov_b32 v31, v16
  s_mov_b32 exec_lo, -1
  v_max3_f32 v124, v16, v17, v18
  v_min3_f32 v126, v16, v17, v18
  v_max3_f32 v124, v124, v19, v20
  v_min3_f32 v126, v126, v19, v20
  v_max3_f32 v124, v124, v21, v22
  v_min3_f32 v126, v126, v21, v22
  v_max3_f32 v124, v124, v23, v24
  v_min3_f32 v126, v126, v23, v24
  v_max3_f32 v124, v124, v25, v26
  v_min3_f32 v126, v126, v25, v26
  v_max3_f32 v124, v124, v27, v28
  v_min3_f32 v126, v126, v27, v28
  v_max3_f32 v124, v124, v29, v30
  v_min3_f32 v126, v126, v29, v30
  v_max_f32 v124, v124, v31
  v_min_f32 v126, v126, v31
  v_mov_b32 v120, v124
  v_mov_b32 v121, v126
  s_nop 0
  v_permlane32_swap_b32 v120, v124
  v_permlane32_swap_b32 v121, v126
  v_max_f32 v124, v120, v124
  v_min_f32 v126, v121, v126
  v_mul_f32 v124, v122, v124
  v_mul_f32 v126, v122, v126
  v_pk_fma_f32 v[48:49], v[16:17], v[122:123], v[124:125] op_sel_hi:[1,0,0] neg_lo:[0,0,1] neg_hi:[0,0,1]
  v_pk_fma_f32 v[64:65], v[16:17], v[122:123], v[126:127] op_sel_hi:[1,0,0] neg_lo:[1,0,0] neg_hi:[1,0,0]
  v_pk_fma_f32 v[50:51], v[18:19], v[122:123], v[124:125] op_sel_hi:[1,0,0] neg_lo:[0,0,1] neg_hi:[0,0,1]
  v_pk_fma_f32 v[66:67], v[18:19], v[122:123], v[126:127] op_sel_hi:[1,0,0] neg_lo:[1,0,0] neg_hi:[1,0,0]
  v_pk_fma_f32 v[52:53], v[20:21], v[122:123], v[124:125] op_sel_hi:[1,0,0] neg_lo:[0,0,1] neg_hi:[0,0,1]
  v_pk_fma_f32 v[68:69], v[20:21], v[122:123], v[126:127] op_sel_hi:[1,0,0] neg_lo:[1,0,0] neg_hi:[1,0,0]
  v_pk_fma_f32 v[54:55], v[22:23], v[122:123], v[124:125] op_sel_hi:[1,0,0] neg_lo:[0,0,1] neg_hi:[0,0,1]
  v_pk_fma_f32 v[70:71], v[22:23], v[122:123], v[126:127] op_sel_hi:[1,0,0] neg_lo:[1,0,0] neg_hi:[1,0,0]
  v_pk_fma_f32 v[56:57], v[24:25], v[122:123], v[124:125] op_sel_hi:[1,0,0] neg_lo:[0,0,1] neg_hi:[0,0,1]
  v_pk_fma_f32 v[72:73], v[24:25], v[122:123], v[126:127] op_sel_hi:[1,0,0] neg_lo:[1,0,0] neg_hi:[1,0,0]
  v_pk_fma_f32 v[58:59], v[26:27], v[122:123], v[124:125] op_sel_hi:[1,0,0] neg_lo:[0,0,1] neg_hi:[0,0,1]
  v_pk_fma_f32 v[74:75], v[26:27], v[122:123], v[126:127] op_sel_hi:[1,0,0] neg_lo:[1,0,0] neg_hi:[1,0,0]
  v_pk_fma_f32 v[60:61], v[28:29], v[122:123], v[124:125] op_sel_hi:[1,0,0] neg_lo:[0,0,1] neg_hi:[0,0,1]
  v_pk_fma_f32 v[76:77], v[28:29], v[122:123], v[126:127] op_sel_hi:[1,0,0] neg_lo:[1,0,0] neg_hi:[1,0,0]
  v_pk_fma_f32 v[62:63], v[30:31], v[122:123], v[124:125] op_sel_hi:[1,0,0] neg_lo:[0,0,1] neg_hi:[0,0,1]
  v_pk_fma_f32 v[78:79], v[30:31], v[122:123], v[126:127] op_sel_hi:[1,0,0] neg_lo:[1,0,0] neg_hi:[1,0,0]
  v_exp_f32 v48, v48
  v_exp_f32 v64, v64
  v_exp_f32 v49, v49
  v_exp_f32 v65, v65
  v_exp_f32 v50, v50
  v_exp_f32 v66, v66
  v_exp_f32 v51, v51
  v_exp_f32 v67, v67
  v_exp_f32 v52, v52
  v_exp_f32 v68, v68
  v_exp_f32 v53, v53
  v_exp_f32 v69, v69
  v_exp_f32 v54, v54
  v_exp_f32 v70, v70
  v_exp_f32 v55, v55
  v_exp_f32 v71, v71
  v_exp_f32 v56, v56
  v_exp_f32 v72, v72
  v_exp_f32 v57, v57
  v_exp_f32 v73, v73
  v_exp_f32 v58, v58
  v_exp_f32 v74, v74
  v_exp_f32 v59, v59
  v_exp_f32 v75, v75
  v_exp_f32 v60, v60
  v_exp_f32 v76, v76
  v_exp_f32 v61, v61
  v_exp_f32 v77, v77
  v_exp_f32 v62, v62
  v_exp_f32 v78, v78
  v_exp_f32 v63, v63
  v_exp_f32 v79, v79
  buffer_load_dwordx2 v[104:105], v253, s[48:51], s11 offen sc1
  s_mov_b32 exec_lo, 0
  v_mov_b32 v60, 0
  v_mov_b32 v76, 0
  v_mov_b32 v61, 0
  v_mov_b32 v77, 0
  v_mov_b32 v62, 0
  v_mov_b32 v78, 0
  v_mov_b32 v63, 0
  v_mov_b32 v79, 0
  s_mov_b32 exec_lo, -1
  v_pk_add_f32 v[124:125], v[48:49], v[50:51]
  v_pk_add_f32 v[126:127], v[64:65], v[66:67]
  v_pk_add_f32 v[124:125], v[124:125], v[52:53]
  v_pk_add_f32 v[126:127], v[126:127], v[68:69]
  v_pk_add_f32 v[124:125], v[124:125], v[54:55]
  v_pk_add_f32 v[126:127], v[126:127], v[70:71]
  v_pk_add_f32 v[124:125], v[124:125], v[56:57]
  v_pk_add_f32 v[126:127], v[126:127], v[72:73]
  v_pk_add_f32 v[124:125], v[124:125], v[58:59]
  v_pk_add_f32 v[126:127], v[126:127], v[74:75]
  v_pk_add_f32 v[124:125], v[124:125], v[60:61]
  v_pk_add_f32 v[126:127], v[126:127], v[76:77]
  v_pk_add_f32 v[124:125], v[124:125], v[62:63]
  v_pk_add_f32 v[126:127], v[126:127], v[78:79]
  v_add_f32 v124, v124, v125
  v_add_f32 v126, v126, v127
  v_mov_b32 v120, v124
  v_mov_b32 v121, v126
  s_nop 0
  v_permlane32_swap_b32 v120, v124
  v_permlane32_swap_b32 v121, v126
  v_add_f32 v124, v120, v124
  v_add_f32 v126, v121, v126
  v_rcp_f32 v124, v124
  v_rcp_f32 v126, v126
  s_waitcnt vmcnt(0)
  s_branch Lpc_13
Lpt_11:
  buffer_load_dwordx2 v[104:105], v253, s[48:51], s11 offen sc1
  s_waitcnt vmcnt(0)
Lpc_13:
  v_cmp_ne_u64 vcc, s[38:39], v[104:105]
  s_nop 0
  s_cbranch_vccz Lpd_12
  s_sub_u32 s101, s101, 1
  s_cbranch_scc1 Lpd_12
  s_sleep 1
  s_branch Lpt_11
Lpd_12:
  buffer_load_dwordx4 v[96:99], v15, s[48:51], s12 offen offset:0 sc1
  buffer_load_dwordx4 v[100:103], v15, s[48:51], s12 offen offset:1024 sc1
  v_pk_mul_f32 v[48:49], v[48:49], v[124:125] op_sel_hi:[1,0]
  v_pk_mul_f32 v[50:51], v[50:51], v[124:125] op_sel_hi:[1,0]
  v_cvt_pk_bf16_f32 v80, v48, v49
  v_cvt_pk_bf16_f32 v81, v50, v51
  ds_write_b64 v225, v[80:81]
  v_pk_mul_f32 v[52:53], v[52:53], v[124:125] op_sel_hi:[1,0]
  v_pk_mul_f32 v[54:55], v[54:55], v[124:125] op_sel_hi:[1,0]
  v_cvt_pk_bf16_f32 v82, v52, v53
  v_cvt_pk_bf16_f32 v83, v54, v55
  ds_write_b64 v106, v[82:83]
  v_pk_mul_f32 v[56:57], v[56:57], v[124:125] op_sel_hi:[1,0]
  v_pk_mul_f32 v[58:59], v[58:59], v[124:125] op_sel_hi:[1,0]
  v_cvt_pk_bf16_f32 v84, v56, v57
  v_cvt_pk_bf16_f32 v85, v58, v59
  ds_write_b64 v107, v[84:85]
  v_pk_mul_f32 v[60:61], v[60:61], v[124:125] op_sel_hi:[1,0]
  v_pk_mul_f32 v[62:63], v[62:63], v[124:125] op_sel_hi:[1,0]
  v_cvt_pk_bf16_f32 v86, v60, v61
  v_cvt_pk_bf16_f32 v87, v62, v63
  ds_write_b64 v108, v[86:87]
  v_pk_mul_f32 v[64:65], v[64:65], v[126:127] op_sel_hi:[1,0]
  v_pk_mul_f32 v[66:67], v[66:67], v[126:127] op_sel_hi:[1,0]
  v_cvt_pk_bf16_f32 v88, v64, v65
  v_cvt_pk_bf16_f32 v89, v66, v67
  ds_write_b64 v109, v[88:89]
  v_pk_mul_f32 v[68:69], v[68:69], v[126:127] op_sel_hi:[1,0]
  v_pk_mul_f32 v[70:71], v[70:71], v[126:127] op_sel_hi:[1,0]
  v_cvt_pk_bf16_f32 v90, v68, v69
  v_cvt_pk_bf16_f32 v91, v70, v71
  ds_write_b64 v110, v[90:91]
  v_pk_mul_f32 v[72:73], v[72:73], v[126:127] op_sel_hi:[1,0]
  v_pk_mul_f32 v[74:75], v[74:75], v[126:127] op_sel_hi:[1,0]
  v_cvt_pk_bf16_f32 v92, v72, v73
  v_cvt_pk_bf16_f32 v93, v74, v75
  ds_write_b64 v111, v[92:93]
  v_pk_mul_f32 v[76:77], v[76:77], v[126:127] op_sel_hi:[1,0]
  v_pk_mul_f32 v[78:79], v[78:79], v[126:127] op_sel_hi:[1,0]
  v_cvt_pk_bf16_f32 v94, v76, v77
  v_cvt_pk_bf16_f32 v95, v78, v79
  ds_write_b64 v112, v[94:95]
  s_waitcnt vmcnt(0)
  ds_write_b64 v226, v[96:97]
  ds_write_b64 v113, v[98:99]
  ds_write_b64 v114, v[100:101]
  ds_write_b64 v115, v[102:103]
  v_mov_b32 v26, v250
  v_mov_b32 v27, v251
  v_mov_b32 v30, v250
  v_mov_b32 v31, v251
  s_waitcnt lgkmcnt(0)
  s_barrier
  ds_read_b64_tr_b16 v[32:33], v227 offset:0
  ds_read_b64_tr_b16 v[34:35], v227 offset:2048
  ds_read_b64_tr_b16 v[48:49], v228 offset:0
  ds_read_b64_tr_b16 v[50:51], v228 offset:1024
  ds_read_b64_tr_b16 v[52:53], v202 offset:0
  ds_read_b64_tr_b16 v[54:55], v202 offset:1024
  ds_read_b64_tr_b16 v[36:37], v227 offset:4096
  ds_read_b64_tr_b16 v[38:39], v227 offset:6144
  ds_read_b64_tr_b16 v[56:57], v228 offset:2048
  ds_read_b64_tr_b16 v[58:59], v228 offset:3072
  ds_read_b64_tr_b16 v[60:61], v202 offset:2048
  ds_read_b64_tr_b16 v[62:63], v202 offset:3072
  s_waitcnt lgkmcnt(6)
  ds_read_b64_tr_b16 v[40:41], v227 offset:8192
  ds_read_b64_tr_b16 v[42:43], v227 offset:10240
  ds_read_b64_tr_b16 v[64:65], v228 offset:4096
  ds_read_b64_tr_b16 v[66:67], v228 offset:5120
  ds_read_b64_tr_b16 v[68:69], v202 offset:4096
  ds_read_b64_tr_b16 v[70:71], v202 offset:5120
  v_mfma_f32_16x16x32_bf16 v[16:19], v[32:35], v[48:51], 0
  v_mfma_f32_16x16x32_bf16 v[20:23], v[32:35], v[52:55], 0
  s_waitcnt lgkmcnt(6)
  ds_read_b64_tr_b16 v[44:45], v227 offset:12288
  ds_read_b64_tr_b16 v[46:47], v227 offset:14336
  ds_read_b64_tr_b16 v[72:73], v228 offset:6144
  ds_read_b64_tr_b16 v[74:75], v228 offset:7168
  ds_read_b64_tr_b16 v[76:77], v202 offset:6144
  ds_read_b64_tr_b16 v[78:79], v202 offset:7168
  v_mfma_f32_16x16x32_bf16 v[16:19], v[36:39], v[56:59], v[16:19]
  v_mfma_f32_16x16x32_bf16 v[20:23], v[36:39], v[60:63], v[20:23]
  s_waitcnt lgkmcnt(6)
  v_mfma_f32_16x16x32_bf16 v[16:19], v[40:43], v[64:67], v[16:19]
  v_mfma_f32_16x16x32_bf16 v[20:23], v[40:43], v[68:71], v[20:23]
  s_waitcnt lgkmcnt(0)
  v_mfma_f32_16x16x32_bf16 v[16:19], v[44:47], v[72:75], v[16:19]
  v_mfma_f32_16x16x32_bf16 v[20:23], v[44:47], v[76:79], v[20:23]
  s_nop 6
  v_cvt_pk_bf16_f32 v24, v16, v17
  v_cvt_pk_bf16_f32 v25, v18, v19
  buffer_store_dwordx4 v[24:27], v15, s[52:55], s13 offen sc1
  v_cvt_pk_bf16_f32 v28, v20, v21
  v_cvt_pk_bf16_f32 v29, v22, v23
  buffer_store_dwordx4 v[28:31], v234, s[52:55], s13 offen sc1
  s_add_u32 m0, s35, 57344
  s_add_u32 s37, s19, 0
  buffer_load_dwordx4 v230, s[60:63], s37 offen lds
  s_add_u32 m0, s35, 58368
  s_add_u32 s37, s19, 7168
  buffer_load_dwordx4 v230, s[60:63], s37 offen lds
  s_add_u32 m0, s35, 59392
  s_add_u32 s37, s19, 14336
  buffer_load_dwordx4 v230, s[60:63], s37 offen lds
  s_add_u32 m0, s35, 60416
  s_add_u32 s37, s19, 21504
  buffer_load_dwordx4 v230, s[60:63], s37 offen lds
  s_add_u32 m0, s35, 61440
  s_add_u32 s37, s19, 28672
  buffer_load_dwordx4 v230, s[60:63], s37 offen lds
  s_add_u32 m0, s35, 62464
  s_add_u32 s37, s19, 35840
  buffer_load_dwordx4 v230, s[60:63], s37 offen lds
  s_add_u32 m0, s35, 63488
  s_add_u32 s37, s19, 43008
  buffer_load_dwordx4 v230, s[60:63], s37 offen lds
  v_mov_b32 v2, v230
  v_mov_b32 v4, v232
  v_mov_b32 v6, v233
  v_xor_b32 v7, 64, v233
  s_lshl_b32 s37, s7, 5
  v_xor_b32 v8, s37, v6
  v_xor_b32 v9, s37, v7
  s_lshl_b32 s28, s3, 12
  s_mul_i32 s29, s3, 6144
  v_and_b32 v10, 3, v1
  v_lshlrev_b32 v10, 3, v10
  s_mul_i32 s37, s7, 14336
  s_add_u32 s37, s37, 57344
  v_add_u32 v192, s37, v8
  v_add_u32 v193, s37, v9
  s_add_u32 s37, s28, 114688
  v_add_u32 v194, s37, v8
  v_add_u32 v195, s37, v9
  v_lshrrev_b32 v196, 3, v13
  v_add_u32 v0, 4096, v15
  s_add_u32 s37, s29, 65536
  v_add_u32 v11, s37, v8
  v_add_u32 v12, s37, v9
  s_mul_i32 s37, s95, 14336
  s_add_u32 s24, s21, s37
  s_lshl_b32 s37, s95, 10
  s_add_u32 s25, s90, s37
  s_add_u32 s26, s91, s37
  v_and_b32 v226, 0x70, v229
  v_lshrrev_b32 v225, 3, v1
  v_lshl_add_u32 v226, v225, 17, v226
  s_waitcnt vmcnt(0)
Lpt_14:
  buffer_load_dwordx4 v[128:131], v229, s[52:55], s14 offen sc1
  buffer_load_dwordx4 v[132:135], v229, s[52:55], s34 offen sc1
  s_waitcnt vmcnt(0)
Lpc_16:
  v_cmp_ne_u64 vcc, s[38:39], v[130:131]
  v_cmp_ne_u64 s[96:97], s[38:39], v[134:135]
  s_nop 0
  s_or_b64 vcc, s[96:97], vcc
  s_cbranch_scc0 Lpd_15
  s_sub_u32 s101, s101, 1
  s_cbranch_scc1 Lpd_15
  s_sleep 1
  s_branch Lpt_14
Lpd_15:
  v_lshlrev_b32 v130, 16, v129
  v_and_b32 v131, 0xffff0000, v129
  v_and_b32 v129, 0xffff0000, v128
  v_lshlrev_b32 v128, 16, v128
  v_lshlrev_b32 v134, 16, v133
  v_and_b32 v135, 0xffff0000, v133
  v_and_b32 v133, 0xffff0000, v132
  v_lshlrev_b32 v132, 16, v132
  v_pk_add_f32 v[128:129], v[128:129], v[132:133]
  v_pk_add_f32 v[130:131], v[130:131], v[134:135]
  s_nop 0
  v_add_f32_dpp v128, v128, v128 row_ror:8 row_mask:0xf bank_mask:0xf
  v_add_f32_dpp v129, v129, v129 row_ror:8 row_mask:0xf bank_mask:0xf
  v_add_f32_dpp v130, v130, v130 row_ror:8 row_mask:0xf bank_mask:0xf
  v_add_f32_dpp v131, v131, v131 row_ror:8 row_mask:0xf bank_mask:0xf
  v_mov_b32 v132, v128
  v_mov_b32 v133, v129
  v_mov_b32 v134, v130
  v_mov_b32 v135, v131
  v_permlane16_swap_b32 v132, v128
  v_permlane16_swap_b32 v133, v129
  v_permlane16_swap_b32 v134, v130
  v_permlane16_swap_b32 v135, v131
  v_pk_add_f32 v[128:129], v[128:129], v[132:133]
  v_pk_add_f32 v[130:131], v[130:131], v[134:135]
  v_mov_b32 v132, v128
  v_mov_b32 v133, v129
  v_mov_b32 v134, v130
  v_mov_b32 v135, v131
  v_permlane32_swap_b32 v132, v128
  v_permlane32_swap_b32 v133, v129
  v_permlane32_swap_b32 v134, v130
  v_permlane32_swap_b32 v135, v131
  v_pk_add_f32 v[128:129], v[128:129], v[132:133]
  v_pk_add_f32 v[130:131], v[130:131], v[134:135]
  v_cvt_pk_bf16_f32 v24, v128, v129
  v_cvt_pk_bf16_f32 v25, v130, v131
  buffer_store_dwordx4 v[24:27], v226, s[52:55], s15 offen sc1
  s_barrier
  s_cmp_lg_u32 s36, 0
  s_cbranch_scc1 L_special
  s_waitcnt lgkmcnt(0)
  s_barrier
  s_add_u32 m0, s28, 114688
  s_add_u32 s37, s21, 0
  buffer_load_dwordx4 v2, s[68:71], s37 offen lds
  s_add_u32 m0, s28, 115712
  s_add_u32 s37, s21, 7168
  buffer_load_dwordx4 v2, s[68:71], s37 offen lds
  s_add_u32 m0, s28, 116736
  s_add_u32 s37, s21, 14336
  buffer_load_dwordx4 v2, s[68:71], s37 offen lds
  s_add_u32 m0, s28, 117760
  s_add_u32 s37, s21, 21504
  buffer_load_dwordx4 v2, s[68:71], s37 offen lds
  ds_read_b64_tr_b16 v[128:129], v192 offset:0
  ds_read_b64_tr_b16 v[130:131], v192 offset:1024
  ds_read_b64_tr_b16 v[132:133], v193 offset:0
  ds_read_b64_tr_b16 v[134:135], v193 offset:1024
  ds_read_b64_tr_b16 v[136:137], v192 offset:2048
  ds_read_b64_tr_b16 v[138:139], v192 offset:3072
  ds_read_b64_tr_b16 v[140:141], v193 offset:2048
  ds_read_b64_tr_b16 v[142:143], v193 offset:3072
  s_waitcnt lgkmcnt(4)
  ds_read_b64_tr_b16 v[144:145], v192 offset:3584
  ds_read_b64_tr_b16 v[146:147], v192 offset:4608
  ds_read_b64_tr_b16 v[148:149], v193 offset:3584
  ds_read_b64_tr_b16 v[150:151], v193 offset:4608
  ds_read_b64_tr_b16 v[152:153], v192 offset:5632
  ds_read_b64_tr_b16 v[154:155], v192 offset:6656
  ds_read_b64_tr_b16 v[156:157], v193 offset:5632
  ds_read_b64_tr_b16 v[158:159], v193 offset:6656
  s_waitcnt lgkmcnt(4)
  ds_read_b64_tr_b16 v[160:161], v192 offset:7168
  ds_read_b64_tr_b16 v[162:163], v192 offset:8192
  ds_read_b64_tr_b16 v[164:165], v193 offset:7168
  ds_read_b64_tr_b16 v[166:167], v193 offset:8192
  ds_read_b64_tr_b16 v[168:169], v192 offset:9216
  ds_read_b64_tr_b16 v[170:171], v192 offset:10240
  ds_read_b64_tr_b16 v[172:173], v193 offset:9216
  ds_read_b64_tr_b16 v[174:175], v193 offset:10240
  s_waitcnt lgkmcnt(4)
  ds_read_b64_tr_b16 v[176:177], v192 offset:10752
  ds_read_b64_tr_b16 v[178:179], v192 offset:11776
  ds_read_b64_tr_b16 v[180:181], v193 offset:10752
  ds_read_b64_tr_b16 v[182:183], v193 offset:11776
  ds_read_b64_tr_b16 v[184:185], v192 offset:12800
  ds_read_b64_tr_b16 v[186:187], v192 offset:13824
  ds_read_b64_tr_b16 v[188:189], v193 offset:12800
  ds_read_b64_tr_b16 v[190:191], v193 offset:13824
  s_waitcnt lgkmcnt(0)
  s_mov_b32 exec_lo, 0
  v_mov_b32 v186, 0
  v_mov_b32 v187, 0
  v_mov_b32 v190, 0
  v_mov_b32 v191, 0
  s_mov_b32 exec_lo, -1
  s_barrier
  s_add_u32 m0, s29, 65536
  s_add_u32 s37, s21, 28672
  buffer_load_dwordx4 v2, s[68:71], s37 offen lds
  s_add_u32 m0, s29, 66560
  s_add_u32 s37, s21, 35840
  buffer_load_dwordx4 v2, s[68:71], s37 offen lds
  s_add_u32 m0, s29, 67584
  s_add_u32 s37, s21, 43008
  buffer_load_dwordx4 v2, s[68:71], s37 offen lds
  s_add_u32 m0, s29, 68608
  s_add_u32 s37, s21, 50176
  buffer_load_dwordx4 v2, s[68:71], s37 offen lds
  s_add_u32 m0, s29, 69632
  s_add_u32 s37, s21, 57344
  buffer_load_dwordx4 v2, s[68:71], s37 offen lds
  s_add_u32 m0, s29, 70656
  s_add_u32 s37, s21, 64512
  buffer_load_dwordx4 v2, s[68:71], s37 offen lds
  buffer_load_dwordx4 v[244:247], v4, s[40:43], s22 offen
  buffer_load_ushort v248, v196, s[72:75], s23 offen
  buffer_load_ushort v249, v196, s[72:75], s23 offen offset:64
  s_branch L_stage3
L_special:
  v_lshlrev_b32 v120, 7, v1
  s_lshr_b32 s37, s5, 2
  s_lshl_b32 s37, s37, 3
  s_add_u32 s37, s37, s3
  s_lshl_b32 s37, s37, 13
  s_add_u32 s93, s37, 524288
  v_min_u32 v121, 2, v1
  v_lshlrev_b32 v121, 7, v121
  s_mul_i32 s37, s37, 3
  s_lshr_b32 s37, s37, 6
  s_add_u32 s37, s37, 1015808
  buffer_load_dword v239, v121, s[48:51], s37 offen sc1
  buffer_load_dword v239, v120, s[48:51], s93 offen sc1
  s_add_u32 s93, s93, 0x40000
  buffer_load_dword v239, v120, s[48:51], s93 offen sc1
  v_lshlrev_b32 v120, 7, v1
  v_add_u32 v122, s35, v6
  v_add_u32 v123, s35, v7
  s_lshl_b32 s37, s3, 9
  v_lshlrev_b32 v124, 3, v1
  v_add_u32 v125, s37, v124
  s_waitcnt lgkmcnt(0)
  ds_read_b64_tr_b16 v[64:65], v122 offset:0
  ds_read_b64_tr_b16 v[66:67], v122 offset:1024
  ds_read_b64_tr_b16 v[68:69], v122 offset:2048
  ds_read_b64_tr_b16 v[70:71], v122 offset:3072
  ds_read_b64_tr_b16 v[72:73], v122 offset:4096
  ds_read_b64_tr_b16 v[74:75], v122 offset:5120
  ds_read_b64_tr_b16 v[76:77], v122 offset:6144
  v_mov_b32 v78, 0
  v_mov_b32 v79, 0
  ds_read_b64_tr_b16 v[80:81], v123 offset:0
  ds_read_b64_tr_b16 v[82:83], v123 offset:1024
  ds_read_b64_tr_b16 v[84:85], v123 offset:2048
  ds_read_b64_tr_b16 v[86:87], v123 offset:3072
  ds_read_b64_tr_b16 v[88:89], v123 offset:4096
  ds_read_b64_tr_b16 v[90:91], v123 offset:5120
  ds_read_b64_tr_b16 v[92:93], v123 offset:6144
  v_mov_b32 v94, 0
  v_mov_b32 v95, 0
  s_waitcnt lgkmcnt(0)
  v_mfma_f32_16x16x32_bf16 v[56:59], v[240:243], v[64:67], 0
  v_mfma_f32_16x16x32_bf16 v[60:63], v[240:243], v[80:83], 0
  v_mfma_f32_16x16x32_bf16 v[56:59], v[240:243], v[68:71], v[56:59]
  v_mfma_f32_16x16x32_bf16 v[60:63], v[240:243], v[84:87], v[60:63]
  v_mfma_f32_16x16x32_bf16 v[56:59], v[240:243], v[72:75], v[56:59]
  v_mfma_f32_16x16x32_bf16 v[60:63], v[240:243], v[88:91], v[60:63]
  v_mfma_f32_16x16x32_bf16 v[56:59], v[240:243], v[76:79], v[56:59]
  v_mfma_f32_16x16x32_bf16 v[60:63], v[240:243], v[92:95], v[60:63]
  s_nop 7
  v_mov_b32 v57, v60
  ds_write_b64 v125, v[56:57] offset:57344
  s_waitcnt lgkmcnt(0)
  s_barrier
  s_cmp_eq_u32 s4, 7
  s_cselect_b32 s37, 1, 0
  s_or_b32 s37, s37, s3
  s_cbranch_scc1 Lnocs_17
  ds_read_b64 v[64:65], v124 offset:57344
  ds_read_b64 v[66:67], v124 offset:57856
  ds_read_b64 v[68:69], v124 offset:58368
  ds_read_b64 v[70:71], v124 offset:58880
  ds_read_b64 v[72:73], v124 offset:59392
  ds_read_b64 v[74:75], v124 offset:59904
  ds_read_b64 v[76:77], v124 offset:60416
  ds_read_b64 v[78:79], v124 offset:60928
  s_waitcnt lgkmcnt(0)
  v_pk_add_f32 v[64:65], v[64:65], v[72:73]
  v_pk_add_f32 v[66:67], v[66:67], v[74:75]
  v_pk_add_f32 v[68:69], v[68:69], v[76:77]
  v_pk_add_f32 v[70:71], v[70:71], v[78:79]
  v_pk_add_f32 v[64:65], v[64:65], v[68:69]
  v_pk_add_f32 v[66:67], v[66:67], v[70:71]
  v_pk_add_f32 v[64:65], v[64:65], v[66:67]
  v_mov_b32 v66, v250
  v_mov_b32 v67, v251
  s_mov_b32 exec_hi, 0
  buffer_store_dwordx4 v[64:67], v15, s[52:55], s92 offen sc1
  s_mov_b32 exec_hi, -1
Lnocs_17:
  v_min_u32 v122, 6, v1
  v_lshlrev_b32 v122, 3, v122
  v_mov_b32 v20, 0
  v_mov_b32 v21, 0
  s_lshl_b32 s37, s30, 11
  v_add_u32 v124, s37, v124
Lpt_18:
  buffer_load_dwordx2 v[126:127], v122, s[48:51], s85 offen sc1
  s_waitcnt vmcnt(0)
Lpc_20:
  v_cmp_ne_u64 vcc, s[38:39], v[126:127]
  s_nop 0
  s_cbranch_vccz Lpd_19
  s_sub_u32 s101, s101, 1
  s_cbranch_scc1 Lpd_19
  s_sleep 1
  s_branch Lpt_18
Lpd_19:
  buffer_load_dwordx4 v[32:35], v15, s[48:51], s84 offen offset:0 sc1
  buffer_load_dwordx4 v[36:39], v15, s[48:51], s84 offen offset:1024 sc1
  buffer_load_dwordx4 v[40:43], v15, s[48:51], s84 offen offset:2048 sc1
  buffer_load_dwordx4 v[44:47], v15, s[48:51], s84 offen offset:3072 sc1
  buffer_load_dwordx4 v[48:51], v0, s[48:51], s84 offen offset:0 sc1
  buffer_load_dwordx4 v[52:55], v0, s[48:51], s84 offen offset:1024 sc1
  buffer_load_dwordx4 v[56:59], v0, s[48:51], s84 offen offset:2048 sc1
  s_waitcnt vmcnt(6)
  v_dot2c_f32_bf16 v20, v32, v14
  v_dot2c_f32_bf16 v21, v32, v32
  v_dot2c_f32_bf16 v20, v33, v14
  v_dot2c_f32_bf16 v21, v33, v33
  v_dot2c_f32_bf16 v20, v34, v14
  v_dot2c_f32_bf16 v21, v34, v34
  v_dot2c_f32_bf16 v20, v35, v14
  v_dot2c_f32_bf16 v21, v35, v35
  s_waitcnt vmcnt(5)
  v_dot2c_f32_bf16 v20, v36, v14
  v_dot2c_f32_bf16 v21, v36, v36
  v_dot2c_f32_bf16 v20, v37, v14
  v_dot2c_f32_bf16 v21, v37, v37
  v_dot2c_f32_bf16 v20, v38, v14
  v_dot2c_f32_bf16 v21, v38, v38
  v_dot2c_f32_bf16 v20, v39, v14
  v_dot2c_f32_bf16 v21, v39, v39
  s_waitcnt vmcnt(4)
  v_dot2c_f32_bf16 v20, v40, v14
  v_dot2c_f32_bf16 v21, v40, v40
  v_dot2c_f32_bf16 v20, v41, v14
  v_dot2c_f32_bf16 v21, v41, v41
  v_dot2c_f32_bf16 v20, v42, v14
  v_dot2c_f32_bf16 v21, v42, v42
  v_dot2c_f32_bf16 v20, v43, v14
  v_dot2c_f32_bf16 v21, v43, v43
  s_waitcnt vmcnt(3)
  v_dot2c_f32_bf16 v20, v44, v14
  v_dot2c_f32_bf16 v21, v44, v44
  v_dot2c_f32_bf16 v20, v45, v14
  v_dot2c_f32_bf16 v21, v45, v45
  v_dot2c_f32_bf16 v20, v46, v14
  v_dot2c_f32_bf16 v21, v46, v46
  v_dot2c_f32_bf16 v20, v47, v14
  v_dot2c_f32_bf16 v21, v47, v47
  s_waitcnt vmcnt(2)
  v_dot2c_f32_bf16 v20, v48, v14
  v_dot2c_f32_bf16 v21, v48, v48
  v_dot2c_f32_bf16 v20, v49, v14
  v_dot2c_f32_bf16 v21, v49, v49
  v_dot2c_f32_bf16 v20, v50, v14
  v_dot2c_f32_bf16 v21, v50, v50
  v_dot2c_f32_bf16 v20, v51, v14
  v_dot2c_f32_bf16 v21, v51, v51
  s_waitcnt vmcnt(1)
  v_dot2c_f32_bf16 v20, v52, v14
  v_dot2c_f32_bf16 v21, v52, v52
  v_dot2c_f32_bf16 v20, v53, v14
  v_dot2c_f32_bf16 v21, v53, v53
  v_dot2c_f32_bf16 v20, v54, v14
  v_dot2c_f32_bf16 v21, v54, v54
  v_dot2c_f32_bf16 v20, v55, v14
  v_dot2c_f32_bf16 v21, v55, v55
  s_waitcnt vmcnt(0)
  v_dot2c_f32_bf16 v20, v56, v14
  v_dot2c_f32_bf16 v21, v56, v56
  v_dot2c_f32_bf16 v20, v57, v14
  v_dot2c_f32_bf16 v21, v57, v57
  v_dot2c_f32_bf16 v20, v58, v14
  v_dot2c_f32_bf16 v21, v58, v58
  v_dot2c_f32_bf16 v20, v59, v14
  v_dot2c_f32_bf16 v21, v59, v59
  s_nop 2
  ds_write_b64 v125, v[20:21] offset:61440
  s_waitcnt lgkmcnt(0)
  s_barrier
  s_cmp_lg_u32 s7, 0
  s_cbranch_scc1 L_fin
  ds_read_b64 v[32:33], v124 offset:61952
  ds_read_b64 v[34:35], v124 offset:62464
  ds_read_b64 v[36:37], v124 offset:62976
  s_waitcnt lgkmcnt(0)
  v_pk_add_f32 v[20:21], v[20:21], v[32:33]
  v_pk_add_f32 v[20:21], v[20:21], v[34:35]
  v_pk_add_f32 v[20:21], v[20:21], v[36:37]
  v_mov_b32 v16, v20
  v_mov_b32 v17, v21
  s_nop 0
  v_permlane32_swap_b32 v16, v20
  v_permlane32_swap_b32 v17, v21
  v_add_f32 v20, v16, v20
  v_add_f32 v21, v17, v21
  v_mul_f32 v20, 0xbb124925, v20
  v_mul_f32 v21, 0x3b124925, v21
  v_fma_f32 v21, -v20, v20, v21
  v_max_f32 v21, 0, v21
  v_add_f32 v21, 0x3727c5ac, v21
  v_rsq_f32 v21, v21
  v_mov_b32 v22, v250
  v_mov_b32 v23, v251
  s_mov_b32 exec_hi, 0
  s_cmp_lg_u32 s100, 0
  s_cbranch_scc1 Lslow_21
  buffer_store_dwordx4 v[20:23], v15, s[48:51], s86 offen
  s_branch Lpe_22
Lslow_21:
  buffer_store_dwordx4 v[20:23], v15, s[48:51], s86 offen sc1
Lpe_22:
  s_mov_b32 exec_hi, -1
  s_branch L_fin
L_roleB:
  s_waitcnt vmcnt(5) lgkmcnt(0)
  v_mfma_f32_32x32x16_bf16 v[16:31], v[144:147], v[64:67], v[16:31]
  s_barrier
  v_mfma_f32_16x16x32_bf16 v[208:211], v[240:243], v[144:147], v[208:211]
  ds_read_b64_tr_b16 v[160:161], v10 offset:24576
  ds_read_b64_tr_b16 v[162:163], v10 offset:25088
  ds_read_b128 v[80:83], v6 offset:49152
  buffer_load_dwordx4 v[176:179], v13, s[48:51], s9 offen sc1
  buffer_load_dwordx4 v[180:183], v13, s[52:55], s33 offen sc1
  buffer_load_dword v239, v253, s[48:51], s11 offen sc1
  v_mfma_f32_32x32x16_bf16 v[16:31], v[148:151], v[68:71], v[16:31]
  ds_read_b64_tr_b16 v[164:165], v11 offset:24576
  ds_read_b64_tr_b16 v[166:167], v11 offset:25088
  ds_read_b128 v[84:87], v7 offset:49152
  s_lshl_b32 s37, s27, 7
  s_add_u32 s37, s37, s24
  s_add_u32 m0, s28, 81920
  s_nop 0
  buffer_load_dwordx4 v2, s[40:43], s37 offen lds
  v_mfma_f32_32x32x16_bf16 v[16:31], v[152:155], v[72:75], v[16:31]
  ds_read_b64_tr_b16 v[168:169], v12 offset:24576
  ds_read_b64_tr_b16 v[170:171], v12 offset:25088
  ds_read_b128 v[88:91], v8 offset:49152
  buffer_load_dwordx4 v3, s[40:43], s37 offen offset:1024 lds
  v_mfma_f32_32x32x16_bf16 v[16:31], v[156:159], v[76:79], v[16:31]
  ds_read_b64_tr_b16 v[172:173], v0 offset:24576
  ds_read_b64_tr_b16 v[174:175], v0 offset:25088
  ds_read_b128 v[92:95], v9 offset:49152
  s_mul_i32 s37, s27, 172032
  s_add_u32 s37, s37, s25
  s_add_u32 m0, s29, 0
  s_nop 0
  buffer_load_dwordx4 v4, s[44:47], s37 offen lds
  s_add_u32 s27, s27, 1
  s_cmp_eq_u32 s27, 7
  s_cselect_b32 s27, 0, s27
  s_waitcnt vmcnt(8) lgkmcnt(0)
  v_add_u32 v6, 0x10000, v6
  v_add_u32 v7, 0x10000, v7
  v_add_u32 v8, 0x10000, v8
  v_add_u32 v9, 0x10000, v9
  v_mfma_f32_32x32x16_bf16 v[16:31], v[160:163], v[80:83], v[16:31]
  s_barrier
  v_mfma_f32_16x16x32_bf16 v[208:211], v[240:243], v[160:163], v[208:211]
  ds_read_b64_tr_b16 v[144:145], v10 offset:32768
  ds_read_b64_tr_b16 v[146:147], v10 offset:33280
  ds_read_b128 v[96:99], v6 offset:0
  s_lshl_b32 s37, s27, 7
  s_add_u32 s37, s37, s24
  s_add_u32 m0, s28, 98304
  s_nop 0
  buffer_load_dwordx4 v2, s[40:43], s37 offen lds
  v_mfma_f32_32x32x16_bf16 v[16:31], v[164:167], v[84:87], v[16:31]
  ds_read_b64_tr_b16 v[148:149], v11 offset:32768
  ds_read_b64_tr_b16 v[150:151], v11 offset:33280
  ds_read_b128 v[100:103], v7 offset:0
  buffer_load_dwordx4 v3, s[40:43], s37 offen offset:1024 lds
  v_mfma_f32_32x32x16_bf16 v[16:31], v[168:171], v[88:91], v[16:31]
  ds_read_b64_tr_b16 v[152:153], v12 offset:32768
  ds_read_b64_tr_b16 v[154:155], v12 offset:33280
  ds_read_b128 v[104:107], v8 offset:0
  s_mul_i32 s37, s27, 172032
  s_add_u32 s37, s37, s25
  s_add_u32 m0, s29, 8192
  s_nop 0
  buffer_load_dwordx4 v4, s[44:47], s37 offen lds
  s_add_u32 s27, s27, 1
  s_cmp_eq_u32 s27, 7
  s_cselect_b32 s27, 0, s27
  v_mfma_f32_32x32x16_bf16 v[16:31], v[172:175], v[92:95], v[16:31]
  ds_read_b64_tr_b16 v[156:157], v0 offset:32768
  ds_read_b64_tr_b16 v[158:159], v0 offset:33280
  ds_read_b128 v[108:111], v9 offset:0
  s_waitcnt lgkmcnt(8)
  ds_read_b64_tr_b16 v[216:217], v224 offset:0
  ds_read_b64_tr_b16 v[218:219], v224 offset:448
  ds_read_b64_tr_b16 v[220:221], v224 offset:896
  ds_read_b64_tr_b16 v[222:223], v224 offset:1344
  s_waitcnt vmcnt(3) lgkmcnt(0)
  v_mfma_f32_32x32x16_bf16 v[16:31], v[144:147], v[96:99], v[16:31]
  s_barrier
  v_mfma_f32_16x16x32_bf16 v[208:211], v[240:243], v[144:147], v[208:211]
  ds_read_b64_tr_b16 v[160:161], v10 offset:0
  ds_read_b64_tr_b16 v[162:163], v10 offset:512
  ds_read_b128 v[112:115], v6 offset:16384
  s_mul_i32 s37, s27, 172032
  s_add_u32 s37, s37, s26
  s_add_u32 m0, s29, 16384
  s_nop 0
  buffer_load_dwordx4 v4, s[44:47], s37 offen lds
  s_add_u32 s27, s27, 1
  s_cmp_eq_u32 s27, 7
  s_cselect_b32 s27, 0, s27
  v_mfma_f32_32x32x16_bf16 v[16:31], v[148:151], v[100:103], v[16:31]
  ds_read_b64_tr_b16 v[164:165], v11 offset:0
  ds_read_b64_tr_b16 v[166:167], v11 offset:512
  ds_read_b128 v[116:119], v7 offset:16384
  s_mul_i32 s37, s27, 172032
  s_add_u32 s37, s37, s26
  s_add_u32 m0, s29, 24576
  s_nop 0
  buffer_load_dwordx4 v4, s[44:47], s37 offen lds
  s_add_u32 s27, s27, 1
  s_cmp_eq_u32 s27, 7
  s_cselect_b32 s27, 0, s27
  v_mfma_f32_32x32x16_bf16 v[16:31], v[152:155], v[104:107], v[16:31]
  ds_read_b64_tr_b16 v[168:169], v12 offset:0
  ds_read_b64_tr_b16 v[170:171], v12 offset:512
  ds_read_b128 v[120:123], v8 offset:16384
  s_mul_i32 s37, s27, 172032
  s_add_u32 s37, s37, s26
  s_add_u32 m0, s29, 32768
  s_nop 0
  buffer_load_dwordx4 v4, s[44:47], s37 offen lds
  s_add_u32 s27, s27, 1
  s_cmp_eq_u32 s27, 7
  s_cselect_b32 s27, 0, s27
  v_mfma_f32_32x32x16_bf16 v[16:31], v[156:159], v[108:111], v[16:31]
  ds_read_b64_tr_b16 v[172:173], v0 offset:0
  ds_read_b64_tr_b16 v[174:175], v0 offset:512
  ds_read_b128 v[124:127], v9 offset:16384
  ds_write_b32 v198, v208
  s_mov_b32 exec_lo, 0
  v_mov_b32 v222, 0
  v_mov_b32 v223, 0
  s_mov_b32 exec_lo, -1
  s_branch Lpc_25
Lpt_23:
  buffer_load_dwordx4 v[176:179], v13, s[48:51], s9 offen sc1
  buffer_load_dwordx4 v[180:183], v13, s[52:55], s33 offen sc1
  s_waitcnt vmcnt(0)
Lpc_25:
  v_cmp_ne_u64 vcc, s[38:39], v[178:179]
  v_cmp_ne_u64 s[96:97], s[38:39], v[180:181]
  s_nop 0
  s_or_b64 vcc, s[96:97], vcc
  s_cbranch_scc0 Lpd_24
  s_sub_u32 s101, s101, 1
  s_cbranch_scc1 Lpd_24
  s_sleep 1
  s_branch Lpt_23
Lpd_24:
  v_cmp_ne_u32 vcc, s31, v182
  v_cvt_pk_bf16_f32 v184, v176, v176
  v_lshlrev_b32 v212, 16, v184
  v_sub_f32 v212, v176, v212
  v_cvt_pk_bf16_f32 v185, v212, v212
  s_or_b32 s100, vcc_lo, vcc_hi
  v_mul_f32 v5, 1069066811, v177
  v_mov_b32 v178, v177
  v_mov_b32 v186, 0
  v_mov_b32 v187, 0
  v_mov_b32 v190, 0
  v_mov_b32 v191, 0
  s_mov_b32 exec_lo, 0
  v_mov_b32 v184, 0
  v_mov_b32 v185, 0
  s_mov_b32 exec_lo, -1
  s_waitcnt vmcnt(3) lgkmcnt(0)
  v_mfma_f32_32x32x16_bf16 v[16:31], v[160:163], v[112:115], v[16:31]
  s_barrier
  v_mfma_f32_16x16x32_bf16 v[208:211], v[240:243], v[160:163], 0
  ds_read_b64_tr_b16 v[144:145], v10 offset:8192
  ds_read_b64_tr_b16 v[146:147], v10 offset:8704
  ds_read_b128 v[128:131], v6 offset:32768
  v_mfma_f32_32x32x16_bf16 v[16:31], v[164:167], v[116:119], v[16:31]
  v_mfma_f32_16x16x32_bf16 v[208:211], v[240:243], v[164:167], v[208:211]
  ds_read_b64_tr_b16 v[148:149], v11 offset:8192
  ds_read_b64_tr_b16 v[150:151], v11 offset:8704
  ds_read_b128 v[132:135], v7 offset:32768
  v_mfma_f32_32x32x16_bf16 v[16:31], v[168:171], v[120:123], v[16:31]
  v_mfma_f32_16x16x32_bf16 v[208:211], v[240:243], v[168:171], v[208:211]
  ds_read_b64_tr_b16 v[152:153], v12 offset:8192
  ds_read_b64_tr_b16 v[154:155], v12 offset:8704
  ds_read_b128 v[136:139], v8 offset:32768
  v_mfma_f32_32x32x16_bf16 v[16:31], v[172:175], v[124:127], v[16:31]
  v_mfma_f32_16x16x32_bf16 v[208:211], v[240:243], v[172:175], v[208:211]
  ds_read_b64_tr_b16 v[156:157], v0 offset:8192
  ds_read_b64_tr_b16 v[158:159], v0 offset:8704
  ds_read_b128 v[140:143], v9 offset:32768
  ds_read_b128 v[204:207], v235
  s_waitcnt lgkmcnt(0)
  v_mfma_f32_16x16x32_bf16 v[208:211], v[240:243], v[144:147], v[208:211]
  v_mfma_f32_16x16x32_bf16 v[208:211], v[240:243], v[148:151], v[208:211]
  v_mfma_f32_16x16x32_bf16 v[208:211], v[240:243], v[152:155], v[208:211]
  v_mfma_f32_16x16x32_bf16 v[208:211], v[240:243], v[156:159], v[208:211]
  v_mfma_f32_32x32x16_bf16 v[16:31], v[144:147], v[128:131], v[16:31]
  v_add_f32 v204, v204, v205
  v_add_f32 v206, v206, v207
  v_add_f32 v204, v204, v206
  v_mfma_f32_32x32x16_bf16 v[16:31], v[148:151], v[132:135], v[16:31]
  v_mfma_f32_32x32x16_bf16 v[16:31], v[152:155], v[136:139], v[16:31]
  s_nop 1
  v_add_f32 v208, v208, v204
  v_cvt_pk_bf16_f32 v212, v208, v208
  v_lshlrev_b32 v212, 16, v212
  v_sub_f32 v212, v208, v212
  v_cvt_pk_bf16_f32 v188, v208, v212
  v_mov_b32 v189, v188
  v_mfma_f32_32x32x16_bf16 v[16:31], v[156:159], v[140:143], v[16:31]
  s_nop 0
  v_mfma_f32_32x32x16_bf16 v[16:31], v[188:191], v[184:187], v[16:31]
  s_nop 11
  v_pk_mul_f32 v[16:17], v[16:17], v[178:179] op_sel_hi:[1,0]
  v_pk_mul_f32 v[18:19], v[18:19], v[178:179] op_sel_hi:[1,0]
  v_pk_mul_f32 v[20:21], v[20:21], v[178:179] op_sel_hi:[1,0]
  v_pk_mul_f32 v[22:23], v[22:23], v[178:179] op_sel_hi:[1,0]
  v_pk_mul_f32 v[24:25], v[24:25], v[178:179] op_sel_hi:[1,0]
  v_pk_mul_f32 v[26:27], v[26:27], v[178:179] op_sel_hi:[1,0]
  v_pk_mul_f32 v[28:29], v[28:29], v[178:179] op_sel_hi:[1,0]
  v_pk_mul_f32 v[30:31], v[30:31], v[178:179] op_sel_hi:[1,0]
  v_cvt_pk_bf16_f32 v160, v16, v17
  v_cvt_pk_bf16_f32 v161, v18, v19
  v_cvt_pk_bf16_f32 v162, v20, v21
  v_cvt_pk_bf16_f32 v163, v22, v23
  v_cvt_pk_bf16_f32 v164, v24, v25
  v_cvt_pk_bf16_f32 v165, v26, v27
  v_cvt_pk_bf16_f32 v166, v28, v29
  v_cvt_pk_bf16_f32 v167, v30, v31
  s_mov_b32 exec_lo, 0
  v_mov_b32 v166, 0x3f80
  v_mov_b32 v167, 0
  s_mov_b32 exec_lo, -1
  buffer_store_dwordx4 v[160:163], v15, s[48:51], s12 offen offset:0 sc1
  buffer_store_dwordx4 v[164:167], v15, s[48:51], s12 offen offset:1024 sc1
  s_barrier
  s_mul_i32 s37, s27, 172032
  s_add_u32 s37, s37, s26
  s_add_u32 m0, s29, 0
  s_nop 0
  buffer_load_dwordx4 v4, s[44:47], s37 offen lds
  s_add_u32 s27, s27, 1
  s_cmp_eq_u32 s27, 7
  s_cselect_b32 s27, 0, s27
  s_mul_i32 s37, s27, 172032
  s_add_u32 s37, s37, s26
  s_add_u32 m0, s29, 8192
  s_nop 0
  buffer_load_dwordx4 v4, s[44:47], s37 offen lds
  s_add_u32 s27, s27, 1
  s_cmp_eq_u32 s27, 7
  s_cselect_b32 s27, 0, s27
  s_waitcnt vmcnt(2)
  s_mov_b64 exec, 1
  s_cmp_lg_u32 s100, 0
  s_cbranch_scc1 Lslow_26
  buffer_store_dwordx2 v[250:251], v253, s[48:51], s11 offen
  s_branch Lpe_27
Lslow_26:
  buffer_store_dwordx2 v[250:251], v253, s[48:51], s11 offen sc1
Lpe_27:
  s_mov_b64 exec, -1
  s_waitcnt lgkmcnt(0)
  s_barrier
  ds_read_b64_tr_b16 v[160:161], v10 offset:16384
  ds_read_b64_tr_b16 v[162:163], v10 offset:16896
  ds_read_b64_tr_b16 v[164:165], v11 offset:16384
  ds_read_b64_tr_b16 v[166:167], v11 offset:16896
  ds_read_b64_tr_b16 v[168:169], v12 offset:16384
  ds_read_b64_tr_b16 v[170:171], v12 offset:16896
  ds_read_b64_tr_b16 v[172:173], v0 offset:16384
  ds_read_b64_tr_b16 v[174:175], v0 offset:16896
  s_waitcnt lgkmcnt(0)
  v_mfma_f32_32x32x16_bf16 v[16:31], v[160:163], v[32:35], 0
  s_barrier
  v_mfma_f32_16x16x32_bf16 v[208:211], v[240:243], v[160:163], 0
  ds_read_b64_tr_b16 v[144:145], v10 offset:24576
  ds_read_b64_tr_b16 v[146:147], v10 offset:25088
  s_mul_i32 s37, s27, 172032
  s_add_u32 s37, s37, s26
  s_add_u32 m0, s29, 16384
  s_nop 0
  buffer_load_dwordx4 v4, s[44:47], s37 offen lds
  s_add_u32 s27, s27, 1
  s_cmp_eq_u32 s27, 7
  s_cselect_b32 s27, 0, s27
  v_mfma_f32_32x32x16_bf16 v[16:31], v[164:167], v[36:39], v[16:31]
  ds_read_b64_tr_b16 v[148:149], v11 offset:24576
  ds_read_b64_tr_b16 v[150:151], v11 offset:25088
  v_mfma_f32_32x32x16_bf16 v[16:31], v[168:171], v[40:43], v[16:31]
  ds_read_b64_tr_b16 v[152:153], v12 offset:24576
  ds_read_b64_tr_b16 v[154:155], v12 offset:25088
  v_mfma_f32_32x32x16_bf16 v[16:31], v[172:175], v[44:47], v[16:31]
  ds_read_b64_tr_b16 v[156:157], v0 offset:24576
  ds_read_b64_tr_b16 v[158:159], v0 offset:25088
  s_waitcnt lgkmcnt(0)
  v_mfma_f32_32x32x16_bf16 v[16:31], v[144:147], v[48:51], v[16:31]
  s_barrier
  v_mfma_f32_16x16x32_bf16 v[208:211], v[240:243], v[144:147], v[208:211]
  ds_read_b64_tr_b16 v[160:161], v10 offset:32768
  ds_read_b64_tr_b16 v[162:163], v10 offset:33280
  s_mul_i32 s37, s27, 172032
  s_add_u32 s37, s37, s26
  s_add_u32 m0, s29, 24576
  s_nop 0
  buffer_load_dwordx4 v4, s[44:47], s37 offen lds
  s_add_u32 s27, s27, 1
  s_cmp_eq_u32 s27, 7
  s_cselect_b32 s27, 0, s27
  v_mfma_f32_32x32x16_bf16 v[16:31], v[148:151], v[52:55], v[16:31]
  ds_read_b64_tr_b16 v[164:165], v11 offset:32768
  ds_read_b64_tr_b16 v[166:167], v11 offset:33280
  s_add_u32 m0, s35, 57344
  s_add_u32 s37, s19, 0
  buffer_load_dwordx4 v230, s[60:63], s37 offen lds
  v_mfma_f32_32x32x16_bf16 v[16:31], v[152:155], v[56:59], v[16:31]
  ds_read_b64_tr_b16 v[168:169], v12 offset:32768
  ds_read_b64_tr_b16 v[170:171], v12 offset:33280
  s_add_u32 m0, s35, 58368
  s_add_u32 s37, s19, 7168
  buffer_load_dwordx4 v230, s[60:63], s37 offen lds
  v_mfma_f32_32x32x16_bf16 v[16:31], v[156:159], v[60:63], v[16:31]
  ds_read_b64_tr_b16 v[172:173], v0 offset:32768
  ds_read_b64_tr_b16 v[174:175], v0 offset:33280
  s_waitcnt vmcnt(6) lgkmcnt(0)
  v_mfma_f32_32x32x16_bf16 v[16:31], v[160:163], v[64:67], v[16:31]
  s_barrier
  v_mfma_f32_16x16x32_bf16 v[208:211], v[240:243], v[160:163], v[208:211]
  ds_read_b64_tr_b16 v[144:145], v10 offset:0
  ds_read_b64_tr_b16 v[146:147], v10 offset:512
  s_add_u32 m0, s35, 59392
  s_add_u32 s37, s19, 14336
  buffer_load_dwordx4 v230, s[60:63], s37 offen lds
  v_mfma_f32_32x32x16_bf16 v[16:31], v[164:167], v[68:71], v[16:31]
  ds_read_b64_tr_b16 v[148:149], v11 offset:0
  ds_read_b64_tr_b16 v[150:151], v11 offset:512
  s_add_u32 m0, s35, 60416
  s_add_u32 s37, s19, 21504
  buffer_load_dwordx4 v230, s[60:63], s37 offen lds
  v_mfma_f32_32x32x16_bf16 v[16:31], v[168:171], v[72:75], v[16:31]
  ds_read_b64_tr_b16 v[152:153], v12 offset:0
  ds_read_b64_tr_b16 v[154:155], v12 offset:512
  v_mfma_f32_32x32x16_bf16 v[16:31], v[172:175], v[76:79], v[16:31]
  ds_read_b64_tr_b16 v[156:157], v0 offset:0
  ds_read_b64_tr_b16 v[158:159], v0 offset:512
  s_waitcnt vmcnt(7) lgkmcnt(0)
  v_mfma_f32_32x32x16_bf16 v[16:31], v[144:147], v[80:83], v[16:31]
  s_barrier
  v_mfma_f32_16x16x32_bf16 v[208:211], v[240:243], v[144:147], v[208:211]
  ds_read_b64_tr_b16 v[160:161], v10 offset:8192
  ds_read_b64_tr_b16 v[162:163], v10 offset:8704
  s_add_u32 m0, s35, 61440
  s_add_u32 s37, s19, 28672
  buffer_load_dwordx4 v230, s[60:63], s37 offen lds
  v_mfma_f32_32x32x16_bf16 v[16:31], v[148:151], v[84:87], v[16:31]
  ds_read_b64_tr_b16 v[164:165], v11 offset:8192
  ds_read_b64_tr_b16 v[166:167], v11 offset:8704
  s_add_u32 m0, s35, 62464
  s_add_u32 s37, s19, 35840
  buffer_load_dwordx4 v230, s[60:63], s37 offen lds
  v_mfma_f32_32x32x16_bf16 v[16:31], v[152:155], v[88:91], v[16:31]
  ds_read_b64_tr_b16 v[168:169], v12 offset:8192
  ds_read_b64_tr_b16 v[170:171], v12 offset:8704
  v_mfma_f32_32x32x16_bf16 v[16:31], v[156:159], v[92:95], v[16:31]
  ds_read_b64_tr_b16 v[172:173], v0 offset:8192
  ds_read_b64_tr_b16 v[174:175], v0 offset:8704
  s_waitcnt vmcnt(7) lgkmcnt(0)
  v_mfma_f32_32x32x16_bf16 v[16:31], v[160:163], v[96:99], v[16:31]
  s_barrier
  v_mfma_f32_16x16x32_bf16 v[208:211], v[240:243], v[160:163], v[208:211]
  ds_read_b64_tr_b16 v[144:145], v10 offset:16384
  ds_read_b64_tr_b16 v[146:147], v10 offset:16896
  s_add_u32 m0, s35, 63488
  s_add_u32 s37, s19, 43008
  buffer_load_dwordx4 v230, s[60:63], s37 offen lds
  v_mfma_f32_32x32x16_bf16 v[16:31], v[164:167], v[100:103], v[16:31]
  ds_read_b64_tr_b16 v[148:149], v11 offset:16384
  ds_read_b64_tr_b16 v[150:151], v11 offset:16896
  v_mfma_f32_32x32x16_bf16 v[16:31], v[168:171], v[104:107], v[16:31]
  ds_read_b64_tr_b16 v[152:153], v12 offset:16384
  ds_read_b64_tr_b16 v[154:155], v12 offset:16896
  v_mfma_f32_32x32x16_bf16 v[16:31], v[172:175], v[108:111], v[16:31]
  ds_read_b64_tr_b16 v[156:157], v0 offset:16384
  ds_read_b64_tr_b16 v[158:159], v0 offset:16896
  ds_write_b32 v198, v208
  s_waitcnt vmcnt(7) lgkmcnt(0)
  v_mfma_f32_32x32x16_bf16 v[16:31], v[144:147], v[112:115], v[16:31]
  s_barrier
  v_mfma_f32_16x16x32_bf16 v[208:211], v[240:243], v[144:147], 0
  ds_read_b64_tr_b16 v[160:161], v10 offset:24576
  ds_read_b64_tr_b16 v[162:163], v10 offset:25088
  v_mfma_f32_32x32x16_bf16 v[16:31], v[148:151], v[116:119], v[16:31]
  v_mfma_f32_16x16x32_bf16 v[208:211], v[240:243], v[148:151], v[208:211]
  ds_read_b64_tr_b16 v[164:165], v11 offset:24576
  ds_read_b64_tr_b16 v[166:167], v11 offset:25088
  v_mfma_f32_32x32x16_bf16 v[16:31], v[152:155], v[120:123], v[16:31]
  v_mfma_f32_16x16x32_bf16 v[208:211], v[240:243], v[152:155], v[208:211]
  ds_read_b64_tr_b16 v[168:169], v12 offset:24576
  ds_read_b64_tr_b16 v[170:171], v12 offset:25088
  v_mfma_f32_32x32x16_bf16 v[16:31], v[156:159], v[124:127], v[16:31]
  v_mfma_f32_16x16x32_bf16 v[208:211], v[240:243], v[156:159], v[208:211]
  ds_read_b64_tr_b16 v[172:173], v0 offset:24576
  ds_read_b64_tr_b16 v[174:175], v0 offset:25088
  ds_read_b128 v[204:207], v235
  s_waitcnt lgkmcnt(0)
  v_mfma_f32_16x16x32_bf16 v[208:211], v[240:243], v[160:163], v[208:211]
  v_mfma_f32_16x16x32_bf16 v[208:211], v[240:243], v[164:167], v[208:211]
  v_mfma_f32_16x16x32_bf16 v[208:211], v[240:243], v[168:171], v[208:211]
  v_mfma_f32_16x16x32_bf16 v[208:211], v[240:243], v[172:175], v[208:211]
  v_mfma_f32_32x32x16_bf16 v[16:31], v[160:163], v[128:131], v[16:31]
  v_add_f32 v204, v204, v205
  v_add_f32 v206, v206, v207
  v_add_f32 v204, v204, v206
  v_mfma_f32_32x32x16_bf16 v[16:31], v[164:167], v[132:135], v[16:31]
  v_mfma_f32_32x32x16_bf16 v[16:31], v[168:171], v[136:139], v[16:31]
  s_nop 1
  v_add_f32 v208, v208, v204
  v_cvt_pk_bf16_f32 v212, v208, v208
  v_lshlrev_b32 v212, 16, v212
  v_sub_f32 v212, v208, v212
  v_cvt_pk_bf16_f32 v188, v208, v212
  v_mov_b32 v189, v188
  v_mfma_f32_32x32x16_bf16 v[16:31], v[172:175], v[140:143], v[16:31]
  s_nop 0
  v_mfma_f32_32x32x16_bf16 v[16:31], v[188:191], v[184:187], v[16:31]
  v_mov_b32 v2, v230
  v_mov_b32 v4, v232
  v_mov_b32 v6, v233
  v_xor_b32 v7, 64, v233
  s_lshl_b32 s37, s7, 5
  v_xor_b32 v8, s37, v6
  v_xor_b32 v9, s37, v7
  s_lshl_b32 s28, s3, 12
  s_mul_i32 s29, s3, 6144
  v_and_b32 v10, 3, v1
  v_lshlrev_b32 v10, 3, v10
  s_mul_i32 s37, s7, 14336
  s_add_u32 s37, s37, 57344
  v_add_u32 v192, s37, v8
  v_add_u32 v193, s37, v9
  s_add_u32 s37, s28, 114688
  v_add_u32 v194, s37, v8
  v_add_u32 v195, s37, v9
  v_lshrrev_b32 v196, 3, v13
  v_add_u32 v0, 4096, v15
  s_add_u32 s37, s29, 65536
  v_add_u32 v11, s37, v8
  v_add_u32 v12, s37, v9
  s_mul_i32 s37, s95, 14336
  s_add_u32 s24, s21, s37
  s_lshl_b32 s37, s95, 10
  s_add_u32 s25, s90, s37
  s_add_u32 s26, s91, s37
  s_waitcnt vmcnt(0)
  s_waitcnt lgkmcnt(0)
  s_barrier
  s_add_u32 m0, s32, 0
  s_add_u32 s37, s20, 0
  buffer_load_dwordx4 v231, s[64:67], s37 offen lds
  s_add_u32 m0, s32, 8192
  s_add_u32 s37, s20, 229376
  buffer_load_dwordx4 v231, s[64:67], s37 offen lds
  s_add_u32 m0, s32, 16384
  s_add_u32 s37, s20, 458752
  buffer_load_dwordx4 v231, s[64:67], s37 offen lds
  s_add_u32 m0, s32, 24576
  s_add_u32 s37, s20, 688128
  buffer_load_dwordx4 v231, s[64:67], s37 offen lds
  s_add_u32 m0, s32, 32768
  s_add_u32 s37, s20, 917504
  buffer_load_dwordx4 v231, s[64:67], s37 offen lds
  s_add_u32 m0, s32, 40960
  s_add_u32 s37, s20, 1146880
  buffer_load_dwordx4 v231, s[64:67], s37 offen lds
  s_add_u32 m0, s32, 49152
  s_add_u32 s37, s20, 1376256
  buffer_load_dwordx4 v231, s[64:67], s37 offen lds
  ds_read_b64_tr_b16 v[128:129], v192 offset:0
  ds_read_b64_tr_b16 v[130:131], v192 offset:1024
  ds_read_b64_tr_b16 v[132:133], v193 offset:0
  ds_read_b64_tr_b16 v[134:135], v193 offset:1024
  ds_read_b64_tr_b16 v[136:137], v192 offset:2048
  ds_read_b64_tr_b16 v[138:139], v192 offset:3072
  ds_read_b64_tr_b16 v[140:141], v193 offset:2048
  ds_read_b64_tr_b16 v[142:143], v193 offset:3072
  s_waitcnt lgkmcnt(4)
  ds_read_b64_tr_b16 v[144:145], v192 offset:3584
  ds_read_b64_tr_b16 v[146:147], v192 offset:4608
  ds_read_b64_tr_b16 v[148:149], v193 offset:3584
  ds_read_b64_tr_b16 v[150:151], v193 offset:4608
  ds_read_b64_tr_b16 v[152:153], v192 offset:5632
  ds_read_b64_tr_b16 v[154:155], v192 offset:6656
  ds_read_b64_tr_b16 v[156:157], v193 offset:5632
  ds_read_b64_tr_b16 v[158:159], v193 offset:6656
  s_waitcnt lgkmcnt(4)
  ds_read_b64_tr_b16 v[160:161], v192 offset:7168
  ds_read_b64_tr_b16 v[162:163], v192 offset:8192
  ds_read_b64_tr_b16 v[164:165], v193 offset:7168
  ds_read_b64_tr_b16 v[166:167], v193 offset:8192
  ds_read_b64_tr_b16 v[168:169], v192 offset:9216
  ds_read_b64_tr_b16 v[170:171], v192 offset:10240
  ds_read_b64_tr_b16 v[172:173], v193 offset:9216
  ds_read_b64_tr_b16 v[174:175], v193 offset:10240
  s_waitcnt lgkmcnt(4)
  ds_read_b64_tr_b16 v[176:177], v192 offset:10752
  ds_read_b64_tr_b16 v[178:179], v192 offset:11776
  ds_read_b64_tr_b16 v[180:181], v193 offset:10752
  ds_read_b64_tr_b16 v[182:183], v193 offset:11776
  ds_read_b64_tr_b16 v[184:185], v192 offset:12800
  ds_read_b64_tr_b16 v[186:187], v192 offset:13824
  ds_read_b64_tr_b16 v[188:189], v193 offset:12800
  ds_read_b64_tr_b16 v[190:191], v193 offset:13824
  s_waitcnt lgkmcnt(0)
  s_mov_b32 exec_lo, 0
  v_mov_b32 v186, 0
  v_mov_b32 v187, 0
  v_mov_b32 v190, 0
  v_mov_b32 v191, 0
  s_mov_b32 exec_lo, -1
  s_barrier
  v_cvt_pk_bf16_f32 v32, v16, v17
  v_cvt_pk_bf16_f32 v33, v18, v19
  v_cvt_pk_bf16_f32 v34, v20, v21
  v_cvt_pk_bf16_f32 v35, v22, v23
  v_cvt_pk_bf16_f32 v36, v24, v25
  v_cvt_pk_bf16_f32 v37, v26, v27
  v_cvt_pk_bf16_f32 v38, v28, v29
  v_cvt_pk_bf16_f32 v39, v30, v31
  v_mfma_f32_32x32x16_bf16 v[16:31], v[216:219], v[32:35], 0
  s_nop 0
  v_mfma_f32_32x32x16_bf16 v[16:31], v[220:223], v[36:39], v[16:31]
  v_mov_b32 v122, v5
  s_mov_b32 exec_lo, 0
  s_nop 9
  v_mov_b32 v28, v16
  v_mov_b32 v29, v16
  v_mov_b32 v30, v16
  v_mov_b32 v31, v16
  s_mov_b32 exec_lo, -1
  v_max3_f32 v124, v16, v17, v18
  v_min3_f32 v126, v16, v17, v18
  v_max3_f32 v124, v124, v19, v20
  v_min3_f32 v126, v126, v19, v20
  v_max3_f32 v124, v124, v21, v22
  v_min3_f32 v126, v126, v21, v22
  v_max3_f32 v124, v124, v23, v24
  v_min3_f32 v126, v126, v23, v24
  v_max3_f32 v124, v124, v25, v26
  v_min3_f32 v126, v126, v25, v26
  v_max3_f32 v124, v124, v27, v28
  v_min3_f32 v126, v126, v27, v28
  v_max3_f32 v124, v124, v29, v30
  v_min3_f32 v126, v126, v29, v30
  v_max_f32 v124, v124, v31
  v_min_f32 v126, v126, v31
  v_mov_b32 v120, v124
  v_mov_b32 v121, v126
  s_nop 0
  v_permlane32_swap_b32 v120, v124
  v_permlane32_swap_b32 v121, v126
  v_max_f32 v124, v120, v124
  v_min_f32 v126, v121, v126
  v_mul_f32 v124, v122, v124
  v_mul_f32 v126, v122, v126
  v_pk_fma_f32 v[48:49], v[16:17], v[122:123], v[124:125] op_sel_hi:[1,0,0] neg_lo:[0,0,1] neg_hi:[0,0,1]
  v_pk_fma_f32 v[64:65], v[16:17], v[122:123], v[126:127] op_sel_hi:[1,0,0] neg_lo:[1,0,0] neg_hi:[1,0,0]
  v_pk_fma_f32 v[50:51], v[18:19], v[122:123], v[124:125] op_sel_hi:[1,0,0] neg_lo:[0,0,1] neg_hi:[0,0,1]
  v_pk_fma_f32 v[66:67], v[18:19], v[122:123], v[126:127] op_sel_hi:[1,0,0] neg_lo:[1,0,0] neg_hi:[1,0,0]
  v_pk_fma_f32 v[52:53], v[20:21], v[122:123], v[124:125] op_sel_hi:[1,0,0] neg_lo:[0,0,1] neg_hi:[0,0,1]
  v_pk_fma_f32 v[68:69], v[20:21], v[122:123], v[126:127] op_sel_hi:[1,0,0] neg_lo:[1,0,0] neg_hi:[1,0,0]
  v_pk_fma_f32 v[54:55], v[22:23], v[122:123], v[124:125] op_sel_hi:[1,0,0] neg_lo:[0,0,1] neg_hi:[0,0,1]
  v_pk_fma_f32 v[70:71], v[22:23], v[122:123], v[126:127] op_sel_hi:[1,0,0] neg_lo:[1,0,0] neg_hi:[1,0,0]
  v_pk_fma_f32 v[56:57], v[24:25], v[122:123], v[124:125] op_sel_hi:[1,0,0] neg_lo:[0,0,1] neg_hi:[0,0,1]
  v_pk_fma_f32 v[72:73], v[24:25], v[122:123], v[126:127] op_sel_hi:[1,0,0] neg_lo:[1,0,0] neg_hi:[1,0,0]
  v_pk_fma_f32 v[58:59], v[26:27], v[122:123], v[124:125] op_sel_hi:[1,0,0] neg_lo:[0,0,1] neg_hi:[0,0,1]
  v_pk_fma_f32 v[74:75], v[26:27], v[122:123], v[126:127] op_sel_hi:[1,0,0] neg_lo:[1,0,0] neg_hi:[1,0,0]
  v_pk_fma_f32 v[60:61], v[28:29], v[122:123], v[124:125] op_sel_hi:[1,0,0] neg_lo:[0,0,1] neg_hi:[0,0,1]
  v_pk_fma_f32 v[76:77], v[28:29], v[122:123], v[126:127] op_sel_hi:[1,0,0] neg_lo:[1,0,0] neg_hi:[1,0,0]
  v_pk_fma_f32 v[62:63], v[30:31], v[122:123], v[124:125] op_sel_hi:[1,0,0] neg_lo:[0,0,1] neg_hi:[0,0,1]
  v_pk_fma_f32 v[78:79], v[30:31], v[122:123], v[126:127] op_sel_hi:[1,0,0] neg_lo:[1,0,0] neg_hi:[1,0,0]
  v_exp_f32 v48, v48
  v_exp_f32 v64, v64
  v_exp_f32 v49, v49
  v_exp_f32 v65, v65
  v_exp_f32 v50, v50
  v_exp_f32 v66, v66
  v_exp_f32 v51, v51
  v_exp_f32 v67, v67
  v_exp_f32 v52, v52
  v_exp_f32 v68, v68
  v_exp_f32 v53, v53
  v_exp_f32 v69, v69
  v_exp_f32 v54, v54
  v_exp_f32 v70, v70
  v_exp_f32 v55, v55
  v_exp_f32 v71, v71
  v_exp_f32 v56, v56
  v_exp_f32 v72, v72
  v_exp_f32 v57, v57
  v_exp_f32 v73, v73
  v_exp_f32 v58, v58
  v_exp_f32 v74, v74
  v_exp_f32 v59, v59
  v_exp_f32 v75, v75
  v_exp_f32 v60, v60
  v_exp_f32 v76, v76
  v_exp_f32 v61, v61
  v_exp_f32 v77, v77
  v_exp_f32 v62, v62
  v_exp_f32 v78, v78
  v_exp_f32 v63, v63
  v_exp_f32 v79, v79
  s_mov_b32 exec_lo, 0
  v_mov_b32 v60, 0
  v_mov_b32 v76, 0
  v_mov_b32 v61, 0
  v_mov_b32 v77, 0
  v_mov_b32 v62, 0
  v_mov_b32 v78, 0
  v_mov_b32 v63, 0
  v_mov_b32 v79, 0
  s_mov_b32 exec_lo, -1
  v_pk_add_f32 v[124:125], v[48:49], v[50:51]
  v_pk_add_f32 v[126:127], v[64:65], v[66:67]
  v_pk_add_f32 v[124:125], v[124:125], v[52:53]
  v_pk_add_f32 v[126:127], v[126:127], v[68:69]
  v_pk_add_f32 v[124:125], v[124:125], v[54:55]
  v_pk_add_f32 v[126:127], v[126:127], v[70:71]
  v_pk_add_f32 v[124:125], v[124:125], v[56:57]
  v_pk_add_f32 v[126:127], v[126:127], v[72:73]
  v_pk_add_f32 v[124:125], v[124:125], v[58:59]
  v_pk_add_f32 v[126:127], v[126:127], v[74:75]
  v_pk_add_f32 v[124:125], v[124:125], v[60:61]
  v_pk_add_f32 v[126:127], v[126:127], v[76:77]
  v_pk_add_f32 v[124:125], v[124:125], v[62:63]
  v_pk_add_f32 v[126:127], v[126:127], v[78:79]
  v_add_f32 v124, v124, v125
  v_add_f32 v126, v126, v127
  v_mov_b32 v120, v124
  v_mov_b32 v121, v126
  s_nop 0
  v_permlane32_swap_b32 v120, v124
  v_permlane32_swap_b32 v121, v126
  v_add_f32 v124, v120, v124
  v_add_f32 v126, v121, v126
  v_rcp_f32 v124, v124
  v_rcp_f32 v126, v126
  v_pk_mul_f32 v[48:49], v[48:49], v[124:125] op_sel_hi:[1,0]
  v_pk_mul_f32 v[50:51], v[50:51], v[124:125] op_sel_hi:[1,0]
  v_cvt_pk_bf16_f32 v80, v48, v49
  v_cvt_pk_bf16_f32 v81, v50, v51
  v_pk_mul_f32 v[52:53], v[52:53], v[124:125] op_sel_hi:[1,0]
  v_pk_mul_f32 v[54:55], v[54:55], v[124:125] op_sel_hi:[1,0]
  v_cvt_pk_bf16_f32 v82, v52, v53
  v_cvt_pk_bf16_f32 v83, v54, v55
  v_pk_mul_f32 v[56:57], v[56:57], v[124:125] op_sel_hi:[1,0]
  v_pk_mul_f32 v[58:59], v[58:59], v[124:125] op_sel_hi:[1,0]
  v_cvt_pk_bf16_f32 v84, v56, v57
  v_cvt_pk_bf16_f32 v85, v58, v59
  v_pk_mul_f32 v[60:61], v[60:61], v[124:125] op_sel_hi:[1,0]
  v_pk_mul_f32 v[62:63], v[62:63], v[124:125] op_sel_hi:[1,0]
  v_cvt_pk_bf16_f32 v86, v60, v61
  v_cvt_pk_bf16_f32 v87, v62, v63
  v_pk_mul_f32 v[64:65], v[64:65], v[126:127] op_sel_hi:[1,0]
  v_pk_mul_f32 v[66:67], v[66:67], v[126:127] op_sel_hi:[1,0]
  v_cvt_pk_bf16_f32 v88, v64, v65
  v_cvt_pk_bf16_f32 v89, v66, v67
  v_pk_mul_f32 v[68:69], v[68:69], v[126:127] op_sel_hi:[1,0]
  v_pk_mul_f32 v[70:71], v[70:71], v[126:127] op_sel_hi:[1,0]
  v_cvt_pk_bf16_f32 v90, v68, v69
  v_cvt_pk_bf16_f32 v91, v70, v71
  v_pk_mul_f32 v[72:73], v[72:73], v[126:127] op_sel_hi:[1,0]
  v_pk_mul_f32 v[74:75], v[74:75], v[126:127] op_sel_hi:[1,0]
  v_cvt_pk_bf16_f32 v92, v72, v73
  v_cvt_pk_bf16_f32 v93, v74, v75
  v_pk_mul_f32 v[76:77], v[76:77], v[126:127] op_sel_hi:[1,0]
  v_pk_mul_f32 v[78:79], v[78:79], v[126:127] op_sel_hi:[1,0]
  v_cvt_pk_bf16_f32 v94, v76, v77
  v_cvt_pk_bf16_f32 v95, v78, v79
  buffer_load_dwordx4 v[244:247], v4, s[40:43], s22 offen
  buffer_load_ushort v248, v196, s[72:75], s23 offen
  buffer_load_ushort v249, v196, s[72:75], s23 offen offset:64
  s_add_u32 m0, s28, 114688
  s_add_u32 s37, s21, 0
  buffer_load_dwordx4 v2, s[68:71], s37 offen lds
  s_add_u32 m0, s28, 115712
  s_add_u32 s37, s21, 7168
  buffer_load_dwordx4 v2, s[68:71], s37 offen lds
  s_add_u32 m0, s28, 116736
  s_add_u32 s37, s21, 14336
  buffer_load_dwordx4 v2, s[68:71], s37 offen lds
  s_add_u32 m0, s28, 117760
  s_add_u32 s37, s21, 21504
  buffer_load_dwordx4 v2, s[68:71], s37 offen lds
Lpt_28:
  buffer_load_dwordx4 v[96:99], v15, s[52:55], s16 offen offset:0 sc1
  buffer_load_dwordx4 v[100:103], v15, s[52:55], s16 offen offset:1024 sc1
  s_waitcnt vmcnt(0)
Lpc_30:
  v_cmp_ne_u64 vcc, s[38:39], v[98:99]
  v_cmp_ne_u64 s[96:97], s[38:39], v[102:103]
  s_nop 0
  s_or_b64 vcc, s[96:97], vcc
  s_cbranch_scc0 Lpd_29
  s_sub_u32 s101, s101, 1
  s_cbranch_scc1 Lpd_29
  s_sleep 1
  s_branch Lpt_28
Lpd_29:
  ds_write_b64 v234, v[96:97] offset:0
  ds_write_b64 v234, v[100:101] offset:256
  s_waitcnt lgkmcnt(0)
  s_barrier
  ds_read_b128 v[96:99], v227 offset:0
  ds_read_b128 v[100:103], v227 offset:1024
  ds_read_b128 v[104:107], v227 offset:2048
  ds_read_b128 v[108:111], v227 offset:3072
  s_waitcnt lgkmcnt(3)
  v_mfma_f32_32x32x16_bf16 v[16:31], v[96:99], v[80:83], 0
  s_waitcnt lgkmcnt(2)
  v_mfma_f32_32x32x16_bf16 v[16:31], v[100:103], v[84:87], v[16:31]
  s_waitcnt lgkmcnt(1)
  v_mfma_f32_32x32x16_bf16 v[16:31], v[104:107], v[88:91], v[16:31]
  s_waitcnt lgkmcnt(0)
  v_mfma_f32_32x32x16_bf16 v[16:31], v[108:111], v[92:95], v[16:31]
  s_nop 11
  v_mov_b32 v120, v28
  v_mov_b32 v122, v28
  s_nop 1
  v_permlane32_swap_b32 v120, v122
  v_add_f32 v122, 0x358637bd, v122
  v_rcp_f32 v122, v122
  s_nop 0
  v_pk_mul_f32 v[16:17], v[16:17], v[122:123] op_sel_hi:[1,0]
  v_pk_mul_f32 v[18:19], v[18:19], v[122:123] op_sel_hi:[1,0]
  v_pk_mul_f32 v[20:21], v[20:21], v[122:123] op_sel_hi:[1,0]
  v_pk_mul_f32 v[22:23], v[22:23], v[122:123] op_sel_hi:[1,0]
  v_pk_mul_f32 v[24:25], v[24:25], v[122:123] op_sel_hi:[1,0]
  v_pk_mul_f32 v[26:27], v[26:27], v[122:123] op_sel_hi:[1,0]
  v_pk_mul_f32 v[28:29], v[28:29], v[122:123] op_sel_hi:[1,0]
  v_pk_mul_f32 v[30:31], v[30:31], v[122:123] op_sel_hi:[1,0]
  v_cvt_pk_bf16_f32 v32, v16, v17
  v_cvt_pk_bf16_f32 v33, v18, v19
  v_cvt_pk_bf16_f32 v34, v20, v21
  v_cvt_pk_bf16_f32 v35, v22, v23
  v_cvt_pk_bf16_f32 v36, v24, v25
  v_cvt_pk_bf16_f32 v37, v26, v27
  v_cvt_pk_bf16_f32 v38, v28, v29
  v_cvt_pk_bf16_f32 v39, v30, v31
  s_mov_b32 exec_lo, 0
  v_mov_b32 v38, 0
  v_mov_b32 v39, 0
  s_mov_b32 exec_lo, -1
  s_setprio 3
  s_cmp_lg_u32 s100, 0
  s_cbranch_scc1 Lslow_31
  buffer_store_dwordx4 v[32:35], v15, s[48:51], s17 offen offset:0
  buffer_store_dwordx4 v[36:39], v15, s[48:51], s17 offen offset:1024
  s_branch Lpe_32
Lslow_31:
  buffer_store_dwordx4 v[32:35], v15, s[48:51], s17 offen offset:0 sc1
  buffer_store_dwordx4 v[36:39], v15, s[48:51], s17 offen offset:1024 sc1
Lpe_32:
  s_waitcnt vmcnt(0)
  s_mov_b64 exec, 1
  s_cmp_lg_u32 s100, 0
  s_cbranch_scc1 Lslow_33
  buffer_store_dwordx2 v[250:251], v253, s[48:51], s18 offen
  s_branch Lpe_34
Lslow_33:
  buffer_store_dwordx2 v[250:251], v253, s[48:51], s18 offen sc1
Lpe_34:
  s_mov_b64 exec, -1
  s_setprio 0
  s_add_u32 m0, s29, 65536
  s_add_u32 s37, s21, 28672
  buffer_load_dwordx4 v2, s[68:71], s37 offen lds
  s_add_u32 m0, s29, 66560
  s_add_u32 s37, s21, 35840
  buffer_load_dwordx4 v2, s[68:71], s37 offen lds
  s_add_u32 m0, s29, 67584
  s_add_u32 s37, s21, 43008
  buffer_load_dwordx4 v2, s[68:71], s37 offen lds
  s_add_u32 m0, s29, 68608
  s_add_u32 s37, s21, 50176
  buffer_load_dwordx4 v2, s[68:71], s37 offen lds
  s_add_u32 m0, s29, 69632
  s_add_u32 s37, s21, 57344
  buffer_load_dwordx4 v2, s[68:71], s37 offen lds
  s_add_u32 m0, s29, 70656
  s_add_u32 s37, s21, 64512
  buffer_load_dwordx4 v2, s[68:71], s37 offen lds
L_stage3:
  buffer_load_dwordx2 v[198:199], v10, s[48:51], s81 offen sc1
  s_waitcnt vmcnt(1)
  ds_read_b64_tr_b16 v[200:201], v194 offset:0
  ds_read_b64_tr_b16 v[202:203], v194 offset:1024
  ds_read_b64_tr_b16 v[204:205], v195 offset:0
  ds_read_b64_tr_b16 v[206:207], v195 offset:1024
  ds_read_b64_tr_b16 v[208:209], v194 offset:2048
  ds_read_b64_tr_b16 v[210:211], v194 offset:3072
  ds_read_b64_tr_b16 v[212:213], v195 offset:2048
  ds_read_b64_tr_b16 v[214:215], v195 offset:3072
  s_waitcnt lgkmcnt(2)
  ds_read_b64_tr_b16 v[216:217], v11 offset:0
  ds_read_b64_tr_b16 v[218:219], v11 offset:1024
  ds_read_b64_tr_b16 v[220:221], v12 offset:0
  ds_read_b64_tr_b16 v[222:223], v12 offset:1024
  ds_read_b64_tr_b16 v[224:225], v11 offset:2048
  ds_read_b64_tr_b16 v[226:227], v11 offset:3072
  ds_read_b64_tr_b16 v[228:229], v12 offset:2048
  ds_read_b64_tr_b16 v[230:231], v12 offset:3072
  ds_read_b64_tr_b16 v[232:233], v11 offset:4096
  ds_read_b64_tr_b16 v[234:235], v11 offset:5120
  ds_read_b64_tr_b16 v[236:237], v12 offset:4096
  ds_read_b64_tr_b16 v[238:239], v12 offset:5120
  v_permlane32_swap_b32 v244, v246
  v_permlane32_swap_b32 v245, v247
  v_lshlrev_b32 v48, 16, v244
  v_and_b32 v49, 0xffff0000, v244
  v_lshlrev_b32 v50, 16, v245
  v_and_b32 v51, 0xffff0000, v245
  v_lshlrev_b32 v52, 16, v246
  v_and_b32 v53, 0xffff0000, v246
  v_lshlrev_b32 v54, 16, v247
  v_and_b32 v55, 0xffff0000, v247
  s_xor_b32 s37, s3, 1
  s_mul_i32 s37, s37, 6144
  s_add_u32 s37, s37, 114688
  v_add_u32 v193, s37, v15
  s_xor_b32 s37, s3, 2
  s_mul_i32 s37, s37, 6144
  s_add_u32 s37, s37, 116736
  v_add_u32 v194, s37, v15
  s_xor_b32 s37, s3, 3
  s_mul_i32 s37, s37, 6144
  s_add_u32 s37, s37, 118784
  v_add_u32 v195, s37, v15
  s_mul_i32 s37, s3, 6144
  s_add_u32 s37, s37, 114688
  v_add_u32 v192, s37, v15
  s_waitcnt lgkmcnt(0)
  s_barrier
  s_waitcnt vmcnt(0)
  s_branch Lpc_37
Lpt_35:
  buffer_load_dwordx2 v[198:199], v10, s[48:51], s81 offen sc1
  s_waitcnt vmcnt(0)
Lpc_37:
  v_cmp_ne_u64 vcc, s[38:39], v[198:199]
  s_nop 0
  s_cbranch_vccz Lpd_36
  s_sub_u32 s101, s101, 1
  s_cbranch_scc1 Lpd_36
  s_sleep 1
  s_branch Lpt_35
Lpd_36:
  buffer_load_dwordx4 v[96:99], v15, s[48:51], s80 offen offset:0 sc1
  buffer_load_dwordx4 v[100:103], v15, s[48:51], s80 offen offset:1024 sc1
  buffer_load_dwordx4 v[104:107], v15, s[48:51], s80 offen offset:2048 sc1
  buffer_load_dwordx4 v[108:111], v15, s[48:51], s80 offen offset:3072 sc1
  buffer_load_dwordx4 v[112:115], v0, s[48:51], s80 offen offset:0 sc1
  buffer_load_dwordx4 v[116:119], v0, s[48:51], s80 offen offset:1024 sc1
  buffer_load_dwordx4 v[120:123], v0, s[48:51], s80 offen offset:2048 sc1
  buffer_load_dwordx4 v[124:127], v0, s[48:51], s80 offen offset:3072 sc1
  buffer_load_dwordx4 v[56:59], v13, s[52:55], s92 offen sc1
  s_waitcnt vmcnt(8)
  v_mfma_f32_32x32x16_bf16 v[32:47], v[132:135], v[96:99], 0
  v_mfma_f32_32x32x16_bf16 v[16:31], v[128:131], v[96:99], 0
  s_add_u32 m0, s29, 65536
  s_add_u32 s37, s21, 71680
  buffer_load_dwordx4 v2, s[68:71], s37 offen lds
  s_waitcnt vmcnt(8)
  v_mfma_f32_32x32x16_bf16 v[32:47], v[140:143], v[100:103], v[32:47]
  v_mfma_f32_32x32x16_bf16 v[16:31], v[136:139], v[100:103], v[16:31]
  s_add_u32 m0, s29, 66560
  s_add_u32 s37, s21, 78848
  buffer_load_dwordx4 v2, s[68:71], s37 offen lds
  s_waitcnt vmcnt(8)
  v_mfma_f32_32x32x16_bf16 v[32:47], v[148:151], v[104:107], v[32:47]
  v_mfma_f32_32x32x16_bf16 v[16:31], v[144:147], v[104:107], v[16:31]
  s_add_u32 m0, s29, 67584
  s_add_u32 s37, s21, 86016
  buffer_load_dwordx4 v2, s[68:71], s37 offen lds
  s_waitcnt vmcnt(8)
  v_mfma_f32_32x32x16_bf16 v[32:47], v[156:159], v[108:111], v[32:47]
  v_mfma_f32_32x32x16_bf16 v[16:31], v[152:155], v[108:111], v[16:31]
  s_add_u32 m0, s29, 68608
  s_add_u32 s37, s21, 93184
  buffer_load_dwordx4 v2, s[68:71], s37 offen lds
  s_waitcnt vmcnt(8)
  v_mfma_f32_32x32x16_bf16 v[32:47], v[164:167], v[112:115], v[32:47]
  v_mfma_f32_32x32x16_bf16 v[16:31], v[160:163], v[112:115], v[16:31]
  s_add_u32 m0, s29, 69632
  s_add_u32 s37, s24, 100352
  buffer_load_dwordx4 v2, s[68:71], s37 offen lds
  s_waitcnt vmcnt(8)
  v_mfma_f32_32x32x16_bf16 v[32:47], v[172:175], v[116:119], v[32:47]
  v_mfma_f32_32x32x16_bf16 v[16:31], v[168:171], v[116:119], v[16:31]
  s_add_u32 m0, s29, 70656
  s_add_u32 s37, s24, 107520
  buffer_load_dwordx4 v2, s[68:71], s37 offen lds
  s_waitcnt vmcnt(8)
  v_mfma_f32_32x32x16_bf16 v[32:47], v[180:183], v[120:123], v[32:47]
  v_mfma_f32_32x32x16_bf16 v[16:31], v[176:179], v[120:123], v[16:31]
  s_waitcnt vmcnt(7)
  v_mfma_f32_32x32x16_bf16 v[32:47], v[188:191], v[124:127], v[32:47]
  v_mfma_f32_32x32x16_bf16 v[16:31], v[184:187], v[124:127], v[16:31]
  s_nop 10
  ds_write_b128 v194, v[32:35] offset:0
  ds_write_b128 v194, v[36:39] offset:1024
  ds_write_b128 v195, v[40:43] offset:0
  ds_write_b128 v195, v[44:47] offset:1024
  ds_write_b128 v193, v[24:27] offset:0
  ds_write_b128 v193, v[28:31] offset:1024
  v_pk_add_f32 v[16:17], v[16:17], v[48:49]
  v_pk_add_f32 v[18:19], v[18:19], v[50:51]
  v_pk_add_f32 v[20:21], v[20:21], v[52:53]
  v_pk_add_f32 v[22:23], v[22:23], v[54:55]
  v_min_u32 v10, 27, v1
  v_lshlrev_b32 v10, 3, v10
  s_waitcnt lgkmcnt(0)
  s_barrier
  ds_read_b128 v[96:99], v192 offset:0
  ds_read_b128 v[100:103], v192 offset:1024
  ds_read_b128 v[104:107], v192 offset:2048
  ds_read_b128 v[108:111], v192 offset:3072
  ds_read_b128 v[112:115], v192 offset:4096
  ds_read_b128 v[116:119], v192 offset:5120
  s_waitcnt lgkmcnt(5)
  v_pk_add_f32 v[16:17], v[16:17], v[96:97]
  v_pk_add_f32 v[18:19], v[18:19], v[98:99]
  s_waitcnt lgkmcnt(4)
  v_pk_add_f32 v[20:21], v[20:21], v[100:101]
  v_pk_add_f32 v[22:23], v[22:23], v[102:103]
  s_waitcnt lgkmcnt(3)
  v_pk_add_f32 v[16:17], v[16:17], v[104:105]
  v_pk_add_f32 v[18:19], v[18:19], v[106:107]
  s_waitcnt lgkmcnt(2)
  v_pk_add_f32 v[20:21], v[20:21], v[108:109]
  v_pk_add_f32 v[22:23], v[22:23], v[110:111]
  s_waitcnt lgkmcnt(1)
  v_pk_add_f32 v[16:17], v[16:17], v[112:113]
  v_pk_add_f32 v[18:19], v[18:19], v[114:115]
  s_waitcnt lgkmcnt(0)
  v_pk_add_f32 v[20:21], v[20:21], v[116:117]
  v_pk_add_f32 v[22:23], v[22:23], v[118:119]
  v_cvt_pk_bf16_f32 v244, v16, v17
  v_cvt_pk_bf16_f32 v245, v18, v19
  v_cvt_pk_bf16_f32 v246, v20, v21
  v_cvt_pk_bf16_f32 v247, v22, v23
  s_setprio 3
  s_cmp_lg_u32 s100, 0
  s_cbranch_scc1 Lslow_38
  buffer_store_dwordx4 v[244:247], v15, s[48:51], s82 offen
  s_branch Lpe_39
Lslow_38:
  buffer_store_dwordx4 v[244:247], v15, s[48:51], s82 offen sc1
Lpe_39:
  s_waitcnt vmcnt(0)
  s_mov_b64 exec, 1
  s_cmp_lg_u32 s100, 0
  s_cbranch_scc1 Lslow_40
  buffer_store_dwordx2 v[250:251], v253, s[48:51], s83 offen
  s_branch Lpe_41
Lslow_40:
  buffer_store_dwordx2 v[250:251], v253, s[48:51], s83 offen sc1
Lpe_41:
  s_mov_b64 exec, -1
  s_setprio 0
  s_add_u32 m0, s29, 114688
  s_add_u32 s37, s24, 114688
  buffer_load_dwordx4 v2, s[68:71], s37 offen lds
  s_add_u32 m0, s29, 115712
  s_add_u32 s37, s24, 121856
  buffer_load_dwordx4 v2, s[68:71], s37 offen lds
  s_add_u32 m0, s29, 116736
  s_add_u32 s37, s24, 129024
  buffer_load_dwordx4 v2, s[68:71], s37 offen lds
  s_add_u32 m0, s29, 117760
  s_add_u32 s37, s24, 136192
  buffer_load_dwordx4 v2, s[68:71], s37 offen lds
  s_add_u32 m0, s29, 118784
  s_add_u32 s37, s24, 143360
  buffer_load_dwordx4 v2, s[68:71], s37 offen lds
  s_add_u32 m0, s29, 119808
  s_add_u32 s37, s24, 150528
  buffer_load_dwordx4 v2, s[68:71], s37 offen lds
  buffer_load_dwordx2 v[240:241], v10, s[48:51], s85 offen sc1
  ds_read_b64_tr_b16 v[128:129], v11 offset:0
  ds_read_b64_tr_b16 v[130:131], v11 offset:1024
  ds_read_b64_tr_b16 v[132:133], v12 offset:0
  ds_read_b64_tr_b16 v[134:135], v12 offset:1024
  ds_read_b64_tr_b16 v[136:137], v11 offset:2048
  ds_read_b64_tr_b16 v[138:139], v11 offset:3072
  ds_read_b64_tr_b16 v[140:141], v12 offset:2048
  ds_read_b64_tr_b16 v[142:143], v12 offset:3072
  ds_read_b64_tr_b16 v[144:145], v11 offset:4096
  ds_read_b64_tr_b16 v[146:147], v11 offset:5120
  ds_read_b64_tr_b16 v[148:149], v12 offset:4096
  ds_read_b64_tr_b16 v[150:151], v12 offset:5120
  s_waitcnt vmcnt(8)
  s_branch Lpc_44
Lpt_42:
  buffer_load_dwordx4 v[56:59], v13, s[52:55], s92 offen sc1
  s_waitcnt vmcnt(0)
Lpc_44:
  v_cmp_ne_u64 vcc, s[38:39], v[58:59]
  s_nop 0
  s_cbranch_vccz Lpd_43
  s_sub_u32 s101, s101, 1
  s_cbranch_scc1 Lpd_43
  s_sleep 1
  s_branch Lpt_42
Lpd_43:
  v_cvt_pk_bf16_f32 v60, v56, v56
  v_lshlrev_b32 v60, 16, v60
  v_sub_f32 v60, v56, v60
  v_cvt_pk_bf16_f32 v72, v56, v60
  v_mov_b32 v73, v72
  v_lshl_or_b32 v74, v248, 16, v248
  v_mov_b32 v75, v248
  v_cvt_pk_bf16_f32 v60, v57, v57
  v_lshlrev_b32 v60, 16, v60
  v_sub_f32 v60, v57, v60
  v_cvt_pk_bf16_f32 v76, v57, v60
  v_mov_b32 v77, v76
  v_lshl_or_b32 v78, v249, 16, v249
  v_mov_b32 v79, v249
  s_mov_b32 exec_lo, 0
  v_mov_b32 v72, 0
  v_mov_b32 v73, 0
  v_mov_b32 v74, 0
  v_mov_b32 v75, 0
  v_mov_b32 v76, 0
  v_mov_b32 v77, 0
  v_mov_b32 v78, 0
  v_mov_b32 v79, 0
  s_mov_b32 exec_lo, -1
  s_waitcnt lgkmcnt(0)
  ds_read_b64_tr_b16 v[48:49], v6 offset:0
  ds_read_b64_tr_b16 v[50:51], v6 offset:1024
  ds_read_b64_tr_b16 v[52:53], v7 offset:0
  ds_read_b64_tr_b16 v[54:55], v7 offset:1024
  ds_read_b64_tr_b16 v[56:57], v6 offset:2048
  ds_read_b64_tr_b16 v[58:59], v6 offset:3072
  ds_read_b64_tr_b16 v[60:61], v7 offset:2048
  ds_read_b64_tr_b16 v[62:63], v7 offset:3072
  s_cmp_ge_u32 s3, 4
  s_cbranch_scc1 Lprio_45
  s_setprio 2
  s_branch Lprio_46
Lprio_45:
  s_setprio 1
Lprio_46:
  s_waitcnt vmcnt(0)
  s_branch Lpc_49
Lpt_47:
  buffer_load_dwordx2 v[240:241], v10, s[48:51], s85 offen sc1
  s_waitcnt vmcnt(0)
Lpc_49:
  v_cmp_ne_u64 vcc, s[38:39], v[240:241]
  s_nop 0
  s_cbranch_vccz Lpd_48
  s_sub_u32 s101, s101, 1
  s_cbranch_scc1 Lpd_48
  s_sleep 1
  s_branch Lpt_47
Lpd_48:
  s_cmp_lt_u32 s3, 4
  s_cbranch_scc1 Lg2w_50
  s_barrier
Lg2w_50:
  buffer_load_dwordx4 v[88:91], v15, s[48:51], s84 offen offset:0 sc1
  buffer_load_dwordx4 v[92:95], v15, s[48:51], s84 offen offset:1024 sc1
  buffer_load_dwordx4 v[96:99], v15, s[48:51], s84 offen offset:2048 sc1
  buffer_load_dwordx4 v[100:103], v15, s[48:51], s84 offen offset:3072 sc1
  s_add_u32 s84, s84, 4096
  buffer_load_dwordx4 v[104:107], v15, s[48:51], s84 offen offset:0 sc1
  buffer_load_dwordx4 v[108:111], v15, s[48:51], s84 offen offset:1024 sc1
  buffer_load_dwordx4 v[112:115], v15, s[48:51], s84 offen offset:2048 sc1
  buffer_load_dwordx4 v[116:119], v15, s[48:51], s84 offen offset:3072 sc1
  s_add_u32 s84, s84, 4096
  buffer_load_dwordx4 v[120:123], v15, s[48:51], s84 offen offset:0 sc1
  s_waitcnt vmcnt(8) lgkmcnt(4)
  v_mfma_f32_32x32x16_bf16 v[16:31], v[48:51], v[88:91], 0
  ds_read_b64_tr_b16 v[64:65], v6 offset:4096
  ds_read_b64_tr_b16 v[66:67], v6 offset:5120
  ds_read_b64_tr_b16 v[68:69], v7 offset:4096
  ds_read_b64_tr_b16 v[70:71], v7 offset:5120
  v_mfma_f32_32x32x16_bf16 v[32:47], v[52:55], v[88:91], 0
  buffer_load_dwordx4 v[124:127], v15, s[48:51], s84 offen offset:1024 sc1
  s_waitcnt vmcnt(8) lgkmcnt(4)
  v_mfma_f32_32x32x16_bf16 v[16:31], v[56:59], v[92:95], v[16:31]
  ds_read_b64_tr_b16 v[48:49], v6 offset:6144
  ds_read_b64_tr_b16 v[50:51], v6 offset:7168
  ds_read_b64_tr_b16 v[52:53], v7 offset:6144
  ds_read_b64_tr_b16 v[54:55], v7 offset:7168
  v_mfma_f32_32x32x16_bf16 v[32:47], v[60:63], v[92:95], v[32:47]
  buffer_load_dwordx4 v[88:91], v15, s[48:51], s84 offen offset:2048 sc1
  s_waitcnt vmcnt(8) lgkmcnt(4)
  v_mfma_f32_32x32x16_bf16 v[16:31], v[64:67], v[96:99], v[16:31]
  ds_read_b64_tr_b16 v[56:57], v6 offset:8192
  ds_read_b64_tr_b16 v[58:59], v6 offset:9216
  ds_read_b64_tr_b16 v[60:61], v7 offset:8192
  ds_read_b64_tr_b16 v[62:63], v7 offset:9216
  v_mfma_f32_32x32x16_bf16 v[32:47], v[68:71], v[96:99], v[32:47]
  buffer_load_dwordx4 v[92:95], v15, s[48:51], s84 offen offset:3072 sc1
  s_waitcnt vmcnt(8) lgkmcnt(4)
  v_mfma_f32_32x32x16_bf16 v[16:31], v[48:51], v[100:103], v[16:31]
  ds_read_b64_tr_b16 v[64:65], v6 offset:10240
  ds_read_b64_tr_b16 v[66:67], v6 offset:11264
  ds_read_b64_tr_b16 v[68:69], v7 offset:10240
  ds_read_b64_tr_b16 v[70:71], v7 offset:11264
  v_mfma_f32_32x32x16_bf16 v[32:47], v[52:55], v[100:103], v[32:47]
  s_add_u32 s84, s84, 4096
  buffer_load_dwordx4 v[96:99], v15, s[48:51], s84 offen offset:0 sc1
  s_waitcnt vmcnt(8) lgkmcnt(4)
  v_mfma_f32_32x32x16_bf16 v[16:31], v[56:59], v[104:107], v[16:31]
  ds_read_b64_tr_b16 v[48:49], v6 offset:12288
  ds_read_b64_tr_b16 v[50:51], v6 offset:13312
  ds_read_b64_tr_b16 v[52:53], v7 offset:12288
  ds_read_b64_tr_b16 v[54:55], v7 offset:13312
  v_mfma_f32_32x32x16_bf16 v[32:47], v[60:63], v[104:107], v[32:47]
  buffer_load_dwordx4 v[100:103], v15, s[48:51], s84 offen offset:1024 sc1
  s_waitcnt vmcnt(8) lgkmcnt(4)
  v_mfma_f32_32x32x16_bf16 v[16:31], v[64:67], v[108:111], v[16:31]
  ds_read_b64_tr_b16 v[56:57], v6 offset:14336
  ds_read_b64_tr_b16 v[58:59], v6 offset:15360
  ds_read_b64_tr_b16 v[60:61], v7 offset:14336
  ds_read_b64_tr_b16 v[62:63], v7 offset:15360
  v_mfma_f32_32x32x16_bf16 v[32:47], v[68:71], v[108:111], v[32:47]
  buffer_load_dwordx4 v[104:107], v15, s[48:51], s84 offen offset:2048 sc1
  s_waitcnt vmcnt(8) lgkmcnt(4)
  v_mfma_f32_32x32x16_bf16 v[16:31], v[48:51], v[112:115], v[16:31]
  ds_read_b64_tr_b16 v[64:65], v6 offset:16384
  ds_read_b64_tr_b16 v[66:67], v6 offset:17408
  ds_read_b64_tr_b16 v[68:69], v7 offset:16384
  ds_read_b64_tr_b16 v[70:71], v7 offset:17408
  v_mfma_f32_32x32x16_bf16 v[32:47], v[52:55], v[112:115], v[32:47]
  buffer_load_dwordx4 v[108:111], v15, s[48:51], s84 offen offset:3072 sc1
  s_waitcnt vmcnt(8) lgkmcnt(4)
  v_mfma_f32_32x32x16_bf16 v[16:31], v[56:59], v[116:119], v[16:31]
  ds_read_b64_tr_b16 v[48:49], v6 offset:18432
  ds_read_b64_tr_b16 v[50:51], v6 offset:19456
  ds_read_b64_tr_b16 v[52:53], v7 offset:18432
  ds_read_b64_tr_b16 v[54:55], v7 offset:19456
  v_mfma_f32_32x32x16_bf16 v[32:47], v[60:63], v[116:119], v[32:47]
  s_add_u32 s84, s84, 4096
  buffer_load_dwordx4 v[112:115], v15, s[48:51], s84 offen offset:0 sc1
  s_waitcnt vmcnt(8) lgkmcnt(4)
  v_mfma_f32_32x32x16_bf16 v[16:31], v[64:67], v[120:123], v[16:31]
  ds_read_b64_tr_b16 v[56:57], v6 offset:20480
  ds_read_b64_tr_b16 v[58:59], v6 offset:21504
  ds_read_b64_tr_b16 v[60:61], v7 offset:20480
  ds_read_b64_tr_b16 v[62:63], v7 offset:21504
  v_mfma_f32_32x32x16_bf16 v[32:47], v[68:71], v[120:123], v[32:47]
  buffer_load_dwordx4 v[116:119], v15, s[48:51], s84 offen offset:1024 sc1
  s_waitcnt vmcnt(8) lgkmcnt(4)
  v_mfma_f32_32x32x16_bf16 v[16:31], v[48:51], v[124:127], v[16:31]
  ds_read_b64_tr_b16 v[64:65], v6 offset:22528
  ds_read_b64_tr_b16 v[66:67], v6 offset:23552
  ds_read_b64_tr_b16 v[68:69], v7 offset:22528
  ds_read_b64_tr_b16 v[70:71], v7 offset:23552
  v_mfma_f32_32x32x16_bf16 v[32:47], v[52:55], v[124:127], v[32:47]
  buffer_load_dwordx4 v[120:123], v15, s[48:51], s84 offen offset:2048 sc1
  s_waitcnt vmcnt(8) lgkmcnt(4)
  v_mfma_f32_32x32x16_bf16 v[16:31], v[56:59], v[88:91], v[16:31]
  ds_read_b64_tr_b16 v[48:49], v6 offset:24576
  ds_read_b64_tr_b16 v[50:51], v6 offset:25600
  ds_read_b64_tr_b16 v[52:53], v7 offset:24576
  ds_read_b64_tr_b16 v[54:55], v7 offset:25600
  v_mfma_f32_32x32x16_bf16 v[32:47], v[60:63], v[88:91], v[32:47]
  buffer_load_dwordx4 v[124:127], v15, s[48:51], s84 offen offset:3072 sc1
  s_waitcnt vmcnt(8) lgkmcnt(4)
  v_mfma_f32_32x32x16_bf16 v[16:31], v[64:67], v[92:95], v[16:31]
  ds_read_b64_tr_b16 v[56:57], v6 offset:26624
  ds_read_b64_tr_b16 v[58:59], v6 offset:27648
  ds_read_b64_tr_b16 v[60:61], v7 offset:26624
  ds_read_b64_tr_b16 v[62:63], v7 offset:27648
  v_mfma_f32_32x32x16_bf16 v[32:47], v[68:71], v[92:95], v[32:47]
  s_add_u32 s84, s84, 4096
  buffer_load_dwordx4 v[88:91], v15, s[48:51], s84 offen offset:0 sc1
  s_waitcnt vmcnt(8) lgkmcnt(4)
  v_mfma_f32_32x32x16_bf16 v[16:31], v[48:51], v[96:99], v[16:31]
  ds_read_b64_tr_b16 v[64:65], v6 offset:28672
  ds_read_b64_tr_b16 v[66:67], v6 offset:29696
  ds_read_b64_tr_b16 v[68:69], v7 offset:28672
  ds_read_b64_tr_b16 v[70:71], v7 offset:29696
  v_mfma_f32_32x32x16_bf16 v[32:47], v[52:55], v[96:99], v[32:47]
  buffer_load_dwordx4 v[92:95], v15, s[48:51], s84 offen offset:1024 sc1
  s_waitcnt vmcnt(8) lgkmcnt(4)
  v_mfma_f32_32x32x16_bf16 v[16:31], v[56:59], v[100:103], v[16:31]
  ds_read_b64_tr_b16 v[48:49], v6 offset:30720
  ds_read_b64_tr_b16 v[50:51], v6 offset:31744
  ds_read_b64_tr_b16 v[52:53], v7 offset:30720
  ds_read_b64_tr_b16 v[54:55], v7 offset:31744
  v_mfma_f32_32x32x16_bf16 v[32:47], v[60:63], v[100:103], v[32:47]
  buffer_load_dwordx4 v[96:99], v15, s[48:51], s84 offen offset:2048 sc1
  s_cmp_ge_u32 s3, 4
  s_cbranch_scc1 Lg1w_51
  s_barrier
Lg1w_51:
  s_waitcnt vmcnt(8) lgkmcnt(4)
  v_mfma_f32_32x32x16_bf16 v[16:31], v[64:67], v[104:107], v[16:31]
  ds_read_b64_tr_b16 v[56:57], v6 offset:32768
  ds_read_b64_tr_b16 v[58:59], v6 offset:33792
  ds_read_b64_tr_b16 v[60:61], v7 offset:32768
  ds_read_b64_tr_b16 v[62:63], v7 offset:33792
  v_mfma_f32_32x32x16_bf16 v[32:47], v[68:71], v[104:107], v[32:47]
  buffer_load_dwordx4 v[100:103], v15, s[48:51], s84 offen offset:3072 sc1
  s_waitcnt vmcnt(8) lgkmcnt(4)
  v_mfma_f32_32x32x16_bf16 v[16:31], v[48:51], v[108:111], v[16:31]
  ds_read_b64_tr_b16 v[64:65], v6 offset:34816
  ds_read_b64_tr_b16 v[66:67], v6 offset:35840
  ds_read_b64_tr_b16 v[68:69], v7 offset:34816
  ds_read_b64_tr_b16 v[70:71], v7 offset:35840
  v_mfma_f32_32x32x16_bf16 v[32:47], v[52:55], v[108:111], v[32:47]
  s_add_u32 s84, s84, 4096
  buffer_load_dwordx4 v[104:107], v15, s[48:51], s84 offen offset:0 sc1
  s_waitcnt vmcnt(8) lgkmcnt(4)
  v_mfma_f32_32x32x16_bf16 v[16:31], v[56:59], v[112:115], v[16:31]
  ds_read_b64_tr_b16 v[48:49], v6 offset:36864
  ds_read_b64_tr_b16 v[50:51], v6 offset:37888
  ds_read_b64_tr_b16 v[52:53], v7 offset:36864
  ds_read_b64_tr_b16 v[54:55], v7 offset:37888
  v_mfma_f32_32x32x16_bf16 v[32:47], v[60:63], v[112:115], v[32:47]
  buffer_load_dwordx4 v[108:111], v15, s[48:51], s84 offen offset:1024 sc1
  s_waitcnt vmcnt(8) lgkmcnt(4)
  v_mfma_f32_32x32x16_bf16 v[16:31], v[64:67], v[116:119], v[16:31]
  ds_read_b64_tr_b16 v[56:57], v6 offset:38912
  ds_read_b64_tr_b16 v[58:59], v6 offset:39936
  ds_read_b64_tr_b16 v[60:61], v7 offset:38912
  ds_read_b64_tr_b16 v[62:63], v7 offset:39936
  v_mfma_f32_32x32x16_bf16 v[32:47], v[68:71], v[116:119], v[32:47]
  buffer_load_dwordx4 v[112:115], v15, s[48:51], s84 offen offset:2048 sc1
  s_waitcnt vmcnt(8) lgkmcnt(4)
  v_mfma_f32_32x32x16_bf16 v[16:31], v[48:51], v[120:123], v[16:31]
  ds_read_b64_tr_b16 v[64:65], v6 offset:40960
  ds_read_b64_tr_b16 v[66:67], v6 offset:41984
  ds_read_b64_tr_b16 v[68:69], v7 offset:40960
  ds_read_b64_tr_b16 v[70:71], v7 offset:41984
  v_mfma_f32_32x32x16_bf16 v[32:47], v[52:55], v[120:123], v[32:47]
  buffer_load_dwordx4 v[116:119], v15, s[48:51], s84 offen offset:3072 sc1
  s_waitcnt vmcnt(8) lgkmcnt(4)
  v_mfma_f32_32x32x16_bf16 v[16:31], v[56:59], v[124:127], v[16:31]
  ds_read_b64_tr_b16 v[48:49], v6 offset:43008
  ds_read_b64_tr_b16 v[50:51], v6 offset:44032
  ds_read_b64_tr_b16 v[52:53], v7 offset:43008
  ds_read_b64_tr_b16 v[54:55], v7 offset:44032
  v_mfma_f32_32x32x16_bf16 v[32:47], v[60:63], v[124:127], v[32:47]
  s_waitcnt vmcnt(7) lgkmcnt(4)
  v_mfma_f32_32x32x16_bf16 v[16:31], v[64:67], v[88:91], v[16:31]
  ds_read_b64_tr_b16 v[56:57], v6 offset:45056
  ds_read_b64_tr_b16 v[58:59], v6 offset:46080
  ds_read_b64_tr_b16 v[60:61], v7 offset:45056
  ds_read_b64_tr_b16 v[62:63], v7 offset:46080
  v_mfma_f32_32x32x16_bf16 v[32:47], v[68:71], v[88:91], v[32:47]
  s_waitcnt vmcnt(6) lgkmcnt(4)
  v_mfma_f32_32x32x16_bf16 v[16:31], v[48:51], v[92:95], v[16:31]
  ds_read_b64_tr_b16 v[64:65], v6 offset:47104
  ds_read_b64_tr_b16 v[66:67], v6 offset:48128
  ds_read_b64_tr_b16 v[68:69], v7 offset:47104
  ds_read_b64_tr_b16 v[70:71], v7 offset:48128
  v_mfma_f32_32x32x16_bf16 v[32:47], v[52:55], v[92:95], v[32:47]
  buffer_load_dwordx4 v[80:83], v13, s[48:51], s86 offen sc1
  s_waitcnt vmcnt(6) lgkmcnt(4)
  v_mfma_f32_32x32x16_bf16 v[16:31], v[56:59], v[96:99], v[16:31]
  ds_read_b64_tr_b16 v[48:49], v6 offset:49152
  ds_read_b64_tr_b16 v[50:51], v6 offset:50176
  ds_read_b64_tr_b16 v[52:53], v7 offset:49152
  ds_read_b64_tr_b16 v[54:55], v7 offset:50176
  v_mfma_f32_32x32x16_bf16 v[32:47], v[60:63], v[96:99], v[32:47]
  s_waitcnt vmcnt(5) lgkmcnt(4)
  v_mfma_f32_32x32x16_bf16 v[16:31], v[64:67], v[100:103], v[16:31]
  ds_read_b64_tr_b16 v[56:57], v6 offset:51200
  ds_read_b64_tr_b16 v[58:59], v6 offset:52224
  ds_read_b64_tr_b16 v[60:61], v7 offset:51200
  ds_read_b64_tr_b16 v[62:63], v7 offset:52224
  v_mfma_f32_32x32x16_bf16 v[32:47], v[68:71], v[100:103], v[32:47]
  s_waitcnt vmcnt(4) lgkmcnt(4)
  v_mfma_f32_32x32x16_bf16 v[16:31], v[48:51], v[104:107], v[16:31]
  ds_read_b64_tr_b16 v[64:65], v6 offset:53248
  ds_read_b64_tr_b16 v[66:67], v6 offset:54272
  ds_read_b64_tr_b16 v[68:69], v7 offset:53248
  ds_read_b64_tr_b16 v[70:71], v7 offset:54272
  v_mfma_f32_32x32x16_bf16 v[32:47], v[52:55], v[104:107], v[32:47]
  s_waitcnt vmcnt(3) lgkmcnt(4)
  v_mfma_f32_32x32x16_bf16 v[16:31], v[56:59], v[108:111], v[16:31]
  ds_read_b64_tr_b16 v[48:49], v6 offset:55296
  ds_read_b64_tr_b16 v[50:51], v6 offset:56320
  ds_read_b64_tr_b16 v[52:53], v7 offset:55296
  ds_read_b64_tr_b16 v[54:55], v7 offset:56320
  v_mfma_f32_32x32x16_bf16 v[32:47], v[60:63], v[108:111], v[32:47]
  s_waitcnt vmcnt(0)
  s_branch Lpc_54
Lpt_52:
  buffer_load_dwordx4 v[80:83], v13, s[48:51], s86 offen sc1
  s_waitcnt vmcnt(0)
Lpc_54:
  v_cmp_ne_u64 vcc, s[38:39], v[82:83]
  s_nop 0
  s_cbranch_vccz Lpd_53
  s_sub_u32 s101, s101, 1
  s_cbranch_scc1 Lpd_53
  s_sleep 1
  s_branch Lpt_52
Lpd_53:
  v_cvt_pk_bf16_f32 v84, v80, v80
  v_lshlrev_b32 v240, 16, v84
  v_sub_f32 v240, v80, v240
  v_cvt_pk_bf16_f32 v85, v240, v240
  v_rcp_f32 v241, v81
  v_mul_f32 v80, 1069066811, v81
  v_mov_b32 v82, v81
  v_cvt_pk_bf16_f32 v240, v241, v241
  v_lshlrev_b32 v240, 16, v240
  v_sub_f32 v242, v241, v240
  s_waitcnt lgkmcnt(4)
  v_mfma_f32_32x32x16_bf16 v[16:31], v[64:67], v[112:115], v[16:31]
  v_mfma_f32_32x32x16_bf16 v[32:47], v[68:71], v[112:115], v[32:47]
  v_cvt_pk_bf16_f32 v86, v241, v242
  v_and_b32 v240, 0xffff0000, v86
  v_sub_f32 v242, v242, v240
  v_cvt_pk_bf16_f32 v87, v242, 0
  v_mul_f32 v240, -2.0, v81
  s_waitcnt lgkmcnt(0)
  v_mfma_f32_32x32x16_bf16 v[16:31], v[48:51], v[116:119], v[16:31]
  v_mfma_f32_32x32x16_bf16 v[32:47], v[52:55], v[116:119], v[32:47]
  v_mfma_f32_32x32x16_bf16 v[16:31], v[72:75], v[84:87], v[16:31]
  v_mfma_f32_32x32x16_bf16 v[32:47], v[76:79], v[84:87], v[32:47]
  s_setprio 0
  s_cmp_lt_u32 s3, 4
  s_cbranch_scc1 Lg1_55
  s_add_u32 m0, s29, 65536
  s_add_u32 s37, s24, 157696
  buffer_load_dwordx4 v2, s[68:71], s37 offen lds
  s_add_u32 m0, s29, 66560
  s_add_u32 s37, s24, 164864
  buffer_load_dwordx4 v2, s[68:71], s37 offen lds
  s_add_u32 m0, s29, 67584
  s_add_u32 s37, s24, 172032
  buffer_load_dwordx4 v2, s[68:71], s37 offen lds
  s_add_u32 m0, s29, 68608
  s_add_u32 s37, s24, 179200
  buffer_load_dwordx4 v2, s[68:71], s37 offen lds
  s_add_u32 m0, s29, 69632
  s_add_u32 s37, s24, 186368
  buffer_load_dwordx4 v2, s[68:71], s37 offen lds
  s_add_u32 m0, s29, 70656
  s_add_u32 s37, s24, 193536
  buffer_load_dwordx4 v2, s[68:71], s37 offen lds
  v_pk_mul_f32 v[88:89], v[16:17], v[80:81] op_sel_hi:[1,0]
  v_pk_mul_f32 v[90:91], v[18:19], v[80:81] op_sel_hi:[1,0]
  v_pk_mul_f32 v[92:93], v[20:21], v[80:81] op_sel_hi:[1,0]
  v_pk_mul_f32 v[94:95], v[22:23], v[80:81] op_sel_hi:[1,0]
  v_pk_mul_f32 v[96:97], v[24:25], v[80:81] op_sel_hi:[1,0]
  v_pk_mul_f32 v[98:99], v[26:27], v[80:81] op_sel_hi:[1,0]
  v_pk_mul_f32 v[100:101], v[28:29], v[80:81] op_sel_hi:[1,0]
  v_pk_mul_f32 v[102:103], v[30:31], v[80:81] op_sel_hi:[1,0]
  v_exp_f32 v88, v88
  v_exp_f32 v89, v89
  v_exp_f32 v90, v90
  v_exp_f32 v91, v91
  v_exp_f32 v92, v92
  v_exp_f32 v93, v93
  v_exp_f32 v94, v94
  v_exp_f32 v95, v95
  v_exp_f32 v96, v96
  v_exp_f32 v97, v97
  v_exp_f32 v98, v98
  v_exp_f32 v99, v99
  v_exp_f32 v100, v100
  v_exp_f32 v101, v101
  v_exp_f32 v102, v102
  v_exp_f32 v103, v103
  v_pk_add_f32 v[104:105], v[88:89], 2.0 op_sel_hi:[1,0]
  v_pk_add_f32 v[106:107], v[90:91], 2.0 op_sel_hi:[1,0]
  v_pk_add_f32 v[108:109], v[92:93], 2.0 op_sel_hi:[1,0]
  v_pk_add_f32 v[110:111], v[94:95], 2.0 op_sel_hi:[1,0]
  v_pk_add_f32 v[112:113], v[96:97], 2.0 op_sel_hi:[1,0]
  v_pk_add_f32 v[114:115], v[98:99], 2.0 op_sel_hi:[1,0]
  v_pk_add_f32 v[116:117], v[100:101], 2.0 op_sel_hi:[1,0]
  v_pk_add_f32 v[118:119], v[102:103], 2.0 op_sel_hi:[1,0]
  v_pk_fma_f32 v[88:89], v[88:89], v[104:105], 2.0 op_sel_hi:[1,1,0]
  v_pk_fma_f32 v[90:91], v[90:91], v[106:107], 2.0 op_sel_hi:[1,1,0]
  v_pk_fma_f32 v[92:93], v[92:93], v[108:109], 2.0 op_sel_hi:[1,1,0]
  v_pk_fma_f32 v[94:95], v[94:95], v[110:111], 2.0 op_sel_hi:[1,1,0]
  v_pk_fma_f32 v[96:97], v[96:97], v[112:113], 2.0 op_sel_hi:[1,1,0]
  v_pk_fma_f32 v[98:99], v[98:99], v[114:115], 2.0 op_sel_hi:[1,1,0]
  v_pk_fma_f32 v[100:101], v[100:101], v[116:117], 2.0 op_sel_hi:[1,1,0]
  v_pk_fma_f32 v[102:103], v[102:103], v[118:119], 2.0 op_sel_hi:[1,1,0]
  v_rcp_f32 v88, v88
  v_rcp_f32 v89, v89
  v_rcp_f32 v90, v90
  v_rcp_f32 v91, v91
  v_rcp_f32 v92, v92
  v_rcp_f32 v93, v93
  v_rcp_f32 v94, v94
  v_rcp_f32 v95, v95
  v_rcp_f32 v96, v96
  v_rcp_f32 v97, v97
  v_rcp_f32 v98, v98
  v_rcp_f32 v99, v99
  v_rcp_f32 v100, v100
  v_rcp_f32 v101, v101
  v_rcp_f32 v102, v102
  v_rcp_f32 v103, v103
  v_pk_fma_f32 v[88:89], v[88:89], v[240:241], v[82:83] op_sel_hi:[1,0,0]
  v_pk_fma_f32 v[90:91], v[90:91], v[240:241], v[82:83] op_sel_hi:[1,0,0]
  v_pk_fma_f32 v[92:93], v[92:93], v[240:241], v[82:83] op_sel_hi:[1,0,0]
  v_pk_fma_f32 v[94:95], v[94:95], v[240:241], v[82:83] op_sel_hi:[1,0,0]
  v_pk_fma_f32 v[96:97], v[96:97], v[240:241], v[82:83] op_sel_hi:[1,0,0]
  v_pk_fma_f32 v[98:99], v[98:99], v[240:241], v[82:83] op_sel_hi:[1,0,0]
  v_pk_fma_f32 v[100:101], v[100:101], v[240:241], v[82:83] op_sel_hi:[1,0,0]
  v_pk_fma_f32 v[102:103], v[102:103], v[240:241], v[82:83] op_sel_hi:[1,0,0]
  v_pk_mul_f32 v[16:17], v[16:17], v[88:89]
  v_pk_mul_f32 v[18:19], v[18:19], v[90:91]
  v_pk_mul_f32 v[20:21], v[20:21], v[92:93]
  v_pk_mul_f32 v[22:23], v[22:23], v[94:95]
  v_pk_mul_f32 v[24:25], v[24:25], v[96:97]
  v_pk_mul_f32 v[26:27], v[26:27], v[98:99]
  v_pk_mul_f32 v[28:29], v[28:29], v[100:101]
  v_pk_mul_f32 v[30:31], v[30:31], v[102:103]
  v_cvt_pk_bf16_f32 v56, v16, v17
  v_cvt_pk_bf16_f32 v57, v18, v19
  v_cvt_pk_bf16_f32 v58, v20, v21
  v_cvt_pk_bf16_f32 v59, v22, v23
  v_cvt_pk_bf16_f32 v60, v24, v25
  v_cvt_pk_bf16_f32 v61, v26, v27
  v_cvt_pk_bf16_f32 v62, v28, v29
  v_cvt_pk_bf16_f32 v63, v30, v31
  buffer_store_dwordx4 v[56:59], v15, s[48:51], s87 offen offset:0 sc1
  buffer_store_dwordx4 v[60:63], v15, s[48:51], s87 offen offset:1024 sc1
  v_pk_mul_f32 v[88:89], v[32:33], v[80:81] op_sel_hi:[1,0]
  v_pk_mul_f32 v[90:91], v[34:35], v[80:81] op_sel_hi:[1,0]
  v_pk_mul_f32 v[92:93], v[36:37], v[80:81] op_sel_hi:[1,0]
  v_pk_mul_f32 v[94:95], v[38:39], v[80:81] op_sel_hi:[1,0]
  v_pk_mul_f32 v[96:97], v[40:41], v[80:81] op_sel_hi:[1,0]
  v_pk_mul_f32 v[98:99], v[42:43], v[80:81] op_sel_hi:[1,0]
  v_pk_mul_f32 v[100:101], v[44:45], v[80:81] op_sel_hi:[1,0]
  v_pk_mul_f32 v[102:103], v[46:47], v[80:81] op_sel_hi:[1,0]
  v_exp_f32 v88, v88
  v_exp_f32 v89, v89
  v_exp_f32 v90, v90
  v_exp_f32 v91, v91
  v_exp_f32 v92, v92
  v_exp_f32 v93, v93
  v_exp_f32 v94, v94
  v_exp_f32 v95, v95
  v_exp_f32 v96, v96
  v_exp_f32 v97, v97
  v_exp_f32 v98, v98
  v_exp_f32 v99, v99
  v_exp_f32 v100, v100
  v_exp_f32 v101, v101
  v_exp_f32 v102, v102
  v_exp_f32 v103, v103
  v_pk_add_f32 v[104:105], v[88:89], 2.0 op_sel_hi:[1,0]
  v_pk_add_f32 v[106:107], v[90:91], 2.0 op_sel_hi:[1,0]
  v_pk_add_f32 v[108:109], v[92:93], 2.0 op_sel_hi:[1,0]
  v_pk_add_f32 v[110:111], v[94:95], 2.0 op_sel_hi:[1,0]
  v_pk_add_f32 v[112:113], v[96:97], 2.0 op_sel_hi:[1,0]
  v_pk_add_f32 v[114:115], v[98:99], 2.0 op_sel_hi:[1,0]
  v_pk_add_f32 v[116:117], v[100:101], 2.0 op_sel_hi:[1,0]
  v_pk_add_f32 v[118:119], v[102:103], 2.0 op_sel_hi:[1,0]
  v_pk_fma_f32 v[88:89], v[88:89], v[104:105], 2.0 op_sel_hi:[1,1,0]
  v_pk_fma_f32 v[90:91], v[90:91], v[106:107], 2.0 op_sel_hi:[1,1,0]
  v_pk_fma_f32 v[92:93], v[92:93], v[108:109], 2.0 op_sel_hi:[1,1,0]
  v_pk_fma_f32 v[94:95], v[94:95], v[110:111], 2.0 op_sel_hi:[1,1,0]
  v_pk_fma_f32 v[96:97], v[96:97], v[112:113], 2.0 op_sel_hi:[1,1,0]
  v_pk_fma_f32 v[98:99], v[98:99], v[114:115], 2.0 op_sel_hi:[1,1,0]
  v_pk_fma_f32 v[100:101], v[100:101], v[116:117], 2.0 op_sel_hi:[1,1,0]
  v_pk_fma_f32 v[102:103], v[102:103], v[118:119], 2.0 op_sel_hi:[1,1,0]
  v_rcp_f32 v88, v88
  v_rcp_f32 v89, v89
  v_rcp_f32 v90, v90
  v_rcp_f32 v91, v91
  v_rcp_f32 v92, v92
  v_rcp_f32 v93, v93
  v_rcp_f32 v94, v94
  v_rcp_f32 v95, v95
  v_rcp_f32 v96, v96
  v_rcp_f32 v97, v97
  v_rcp_f32 v98, v98
  v_rcp_f32 v99, v99
  v_rcp_f32 v100, v100
  v_rcp_f32 v101, v101
  v_rcp_f32 v102, v102
  v_rcp_f32 v103, v103
  v_pk_fma_f32 v[88:89], v[88:89], v[240:241], v[82:83] op_sel_hi:[1,0,0]
  v_pk_fma_f32 v[90:91], v[90:91], v[240:241], v[82:83] op_sel_hi:[1,0,0]
  v_pk_fma_f32 v[92:93], v[92:93], v[240:241], v[82:83] op_sel_hi:[1,0,0]
  v_pk_fma_f32 v[94:95], v[94:95], v[240:241], v[82:83] op_sel_hi:[1,0,0]
  v_pk_fma_f32 v[96:97], v[96:97], v[240:241], v[82:83] op_sel_hi:[1,0,0]
  v_pk_fma_f32 v[98:99], v[98:99], v[240:241], v[82:83] op_sel_hi:[1,0,0]
  v_pk_fma_f32 v[100:101], v[100:101], v[240:241], v[82:83] op_sel_hi:[1,0,0]
  v_pk_fma_f32 v[102:103], v[102:103], v[240:241], v[82:83] op_sel_hi:[1,0,0]
  v_pk_mul_f32 v[32:33], v[32:33], v[88:89]
  v_pk_mul_f32 v[34:35], v[34:35], v[90:91]
  v_pk_mul_f32 v[36:37], v[36:37], v[92:93]
  v_pk_mul_f32 v[38:39], v[38:39], v[94:95]
  v_pk_mul_f32 v[40:41], v[40:41], v[96:97]
  v_pk_mul_f32 v[42:43], v[42:43], v[98:99]
  v_pk_mul_f32 v[44:45], v[44:45], v[100:101]
  v_pk_mul_f32 v[46:47], v[46:47], v[102:103]
  v_cvt_pk_bf16_f32 v64, v32, v33
  v_cvt_pk_bf16_f32 v65, v34, v35
  v_cvt_pk_bf16_f32 v66, v36, v37
  v_cvt_pk_bf16_f32 v67, v38, v39
  v_cvt_pk_bf16_f32 v68, v40, v41
  v_cvt_pk_bf16_f32 v69, v42, v43
  v_cvt_pk_bf16_f32 v70, v44, v45
  v_cvt_pk_bf16_f32 v71, v46, v47
  buffer_store_dwordx4 v[64:67], v15, s[48:51], s87 offen offset:2048 sc1
  buffer_store_dwordx4 v[68:71], v15, s[48:51], s87 offen offset:3072 sc1
  s_branch Lg1e_56
Lg1_55:
  s_nop 7
  v_mul_f32 v88, v80, v16
  v_mul_f32 v89, v80, v17
  v_mul_f32 v90, v80, v18
  v_mul_f32 v91, v80, v19
  v_mul_f32 v92, v80, v20
  v_mul_f32 v93, v80, v21
  v_mul_f32 v94, v80, v22
  v_mul_f32 v95, v80, v23
  v_mul_f32 v96, v80, v24
  v_mul_f32 v97, v80, v25
  v_mul_f32 v98, v80, v26
  v_mul_f32 v99, v80, v27
  v_mul_f32 v100, v80, v28
  v_mul_f32 v101, v80, v29
  v_mul_f32 v102, v80, v30
  v_mul_f32 v103, v80, v31
  v_exp_f32 v88, v88
  v_exp_f32 v89, v89
  v_exp_f32 v90, v90
  v_exp_f32 v91, v91
  v_exp_f32 v92, v92
  v_exp_f32 v93, v93
  v_exp_f32 v94, v94
  v_exp_f32 v95, v95
  v_exp_f32 v96, v96
  v_exp_f32 v97, v97
  v_exp_f32 v98, v98
  v_exp_f32 v99, v99
  v_exp_f32 v100, v100
  v_exp_f32 v101, v101
  v_exp_f32 v102, v102
  v_exp_f32 v103, v103
  v_add_f32 v104, 2.0, v88
  v_add_f32 v105, 2.0, v89
  v_add_f32 v106, 2.0, v90
  v_add_f32 v107, 2.0, v91
  v_add_f32 v108, 2.0, v92
  v_add_f32 v109, 2.0, v93
  v_add_f32 v110, 2.0, v94
  v_add_f32 v111, 2.0, v95
  v_add_f32 v112, 2.0, v96
  v_add_f32 v113, 2.0, v97
  v_add_f32 v114, 2.0, v98
  v_add_f32 v115, 2.0, v99
  v_add_f32 v116, 2.0, v100
  v_add_f32 v117, 2.0, v101
  v_add_f32 v118, 2.0, v102
  v_add_f32 v119, 2.0, v103
  v_fma_f32 v88, v88, v104, 2.0
  v_fma_f32 v89, v89, v105, 2.0
  v_fma_f32 v90, v90, v106, 2.0
  v_fma_f32 v91, v91, v107, 2.0
  v_fma_f32 v92, v92, v108, 2.0
  v_fma_f32 v93, v93, v109, 2.0
  v_fma_f32 v94, v94, v110, 2.0
  v_fma_f32 v95, v95, v111, 2.0
  v_fma_f32 v96, v96, v112, 2.0
  v_fma_f32 v97, v97, v113, 2.0
  v_fma_f32 v98, v98, v114, 2.0
  v_fma_f32 v99, v99, v115, 2.0
  v_fma_f32 v100, v100, v116, 2.0
  v_fma_f32 v101, v101, v117, 2.0
  v_fma_f32 v102, v102, v118, 2.0
  v_fma_f32 v103, v103, v119, 2.0
  v_rcp_f32 v88, v88
  v_rcp_f32 v89, v89
  v_rcp_f32 v90, v90
  v_rcp_f32 v91, v91
  v_rcp_f32 v92, v92
  v_rcp_f32 v93, v93
  v_rcp_f32 v94, v94
  v_rcp_f32 v95, v95
  v_rcp_f32 v96, v96
  v_rcp_f32 v97, v97
  v_rcp_f32 v98, v98
  v_rcp_f32 v99, v99
  v_rcp_f32 v100, v100
  v_rcp_f32 v101, v101
  v_rcp_f32 v102, v102
  v_rcp_f32 v103, v103
  v_fma_f32 v88, v88, v240, v81
  v_fma_f32 v89, v89, v240, v81
  v_fma_f32 v90, v90, v240, v81
  v_fma_f32 v91, v91, v240, v81
  v_fma_f32 v92, v92, v240, v81
  v_fma_f32 v93, v93, v240, v81
  v_fma_f32 v94, v94, v240, v81
  v_fma_f32 v95, v95, v240, v81
  v_fma_f32 v96, v96, v240, v81
  v_fma_f32 v97, v97, v240, v81
  v_fma_f32 v98, v98, v240, v81
  v_fma_f32 v99, v99, v240, v81
  v_fma_f32 v100, v100, v240, v81
  v_fma_f32 v101, v101, v240, v81
  v_fma_f32 v102, v102, v240, v81
  v_fma_f32 v103, v103, v240, v81
  v_mul_f32 v16, v16, v88
  v_mul_f32 v17, v17, v89
  v_mul_f32 v18, v18, v90
  v_mul_f32 v19, v19, v91
  v_mul_f32 v20, v20, v92
  v_mul_f32 v21, v21, v93
  v_mul_f32 v22, v22, v94
  v_mul_f32 v23, v23, v95
  v_mul_f32 v24, v24, v96
  v_mul_f32 v25, v25, v97
  v_mul_f32 v26, v26, v98
  v_mul_f32 v27, v27, v99
  v_mul_f32 v28, v28, v100
  v_mul_f32 v29, v29, v101
  v_mul_f32 v30, v30, v102
  v_mul_f32 v31, v31, v103
  v_cvt_pk_bf16_f32 v56, v16, v17
  v_cvt_pk_bf16_f32 v57, v18, v19
  v_cvt_pk_bf16_f32 v58, v20, v21
  v_cvt_pk_bf16_f32 v59, v22, v23
  v_cvt_pk_bf16_f32 v60, v24, v25
  v_cvt_pk_bf16_f32 v61, v26, v27
  v_cvt_pk_bf16_f32 v62, v28, v29
  v_cvt_pk_bf16_f32 v63, v30, v31
  buffer_store_dwordx4 v[56:59], v15, s[48:51], s87 offen offset:0 sc1
  buffer_store_dwordx4 v[60:63], v15, s[48:51], s87 offen offset:1024 sc1
  v_mul_f32 v88, v80, v32
  v_mul_f32 v89, v80, v33
  v_mul_f32 v90, v80, v34
  v_mul_f32 v91, v80, v35
  v_mul_f32 v92, v80, v36
  v_mul_f32 v93, v80, v37
  v_mul_f32 v94, v80, v38
  v_mul_f32 v95, v80, v39
  v_mul_f32 v96, v80, v40
  v_mul_f32 v97, v80, v41
  v_mul_f32 v98, v80, v42
  v_mul_f32 v99, v80, v43
  v_mul_f32 v100, v80, v44
  v_mul_f32 v101, v80, v45
  v_mul_f32 v102, v80, v46
  v_mul_f32 v103, v80, v47
  v_exp_f32 v88, v88
  v_exp_f32 v89, v89
  v_exp_f32 v90, v90
  v_exp_f32 v91, v91
  v_exp_f32 v92, v92
  v_exp_f32 v93, v93
  v_exp_f32 v94, v94
  v_exp_f32 v95, v95
  v_exp_f32 v96, v96
  v_exp_f32 v97, v97
  v_exp_f32 v98, v98
  v_exp_f32 v99, v99
  v_exp_f32 v100, v100
  v_exp_f32 v101, v101
  v_exp_f32 v102, v102
  v_exp_f32 v103, v103
  v_add_f32 v104, 2.0, v88
  v_add_f32 v105, 2.0, v89
  v_add_f32 v106, 2.0, v90
  v_add_f32 v107, 2.0, v91
  v_add_f32 v108, 2.0, v92
  v_add_f32 v109, 2.0, v93
  v_add_f32 v110, 2.0, v94
  v_add_f32 v111, 2.0, v95
  v_add_f32 v112, 2.0, v96
  v_add_f32 v113, 2.0, v97
  v_add_f32 v114, 2.0, v98
  v_add_f32 v115, 2.0, v99
  v_add_f32 v116, 2.0, v100
  v_add_f32 v117, 2.0, v101
  v_add_f32 v118, 2.0, v102
  v_add_f32 v119, 2.0, v103
  v_fma_f32 v88, v88, v104, 2.0
  v_fma_f32 v89, v89, v105, 2.0
  v_fma_f32 v90, v90, v106, 2.0
  v_fma_f32 v91, v91, v107, 2.0
  v_fma_f32 v92, v92, v108, 2.0
  v_fma_f32 v93, v93, v109, 2.0
  v_fma_f32 v94, v94, v110, 2.0
  v_fma_f32 v95, v95, v111, 2.0
  v_fma_f32 v96, v96, v112, 2.0
  v_fma_f32 v97, v97, v113, 2.0
  v_fma_f32 v98, v98, v114, 2.0
  v_fma_f32 v99, v99, v115, 2.0
  v_fma_f32 v100, v100, v116, 2.0
  v_fma_f32 v101, v101, v117, 2.0
  v_fma_f32 v102, v102, v118, 2.0
  v_fma_f32 v103, v103, v119, 2.0
  v_rcp_f32 v88, v88
  v_rcp_f32 v89, v89
  v_rcp_f32 v90, v90
  v_rcp_f32 v91, v91
  v_rcp_f32 v92, v92
  v_rcp_f32 v93, v93
  v_rcp_f32 v94, v94
  v_rcp_f32 v95, v95
  v_rcp_f32 v96, v96
  v_rcp_f32 v97, v97
  v_rcp_f32 v98, v98
  v_rcp_f32 v99, v99
  v_rcp_f32 v100, v100
  v_rcp_f32 v101, v101
  v_rcp_f32 v102, v102
  v_rcp_f32 v103, v103
  v_fma_f32 v88, v88, v240, v81
  v_fma_f32 v89, v89, v240, v81
  v_fma_f32 v90, v90, v240, v81
  v_fma_f32 v91, v91, v240, v81
  v_fma_f32 v92, v92, v240, v81
  v_fma_f32 v93, v93, v240, v81
  v_fma_f32 v94, v94, v240, v81
  v_fma_f32 v95, v95, v240, v81
  v_fma_f32 v96, v96, v240, v81
  v_fma_f32 v97, v97, v240, v81
  v_fma_f32 v98, v98, v240, v81
  v_fma_f32 v99, v99, v240, v81
  v_fma_f32 v100, v100, v240, v81
  v_fma_f32 v101, v101, v240, v81
  v_fma_f32 v102, v102, v240, v81
  v_fma_f32 v103, v103, v240, v81
  v_mul_f32 v32, v32, v88
  v_mul_f32 v33, v33, v89
  v_mul_f32 v34, v34, v90
  v_mul_f32 v35, v35, v91
  v_mul_f32 v36, v36, v92
  v_mul_f32 v37, v37, v93
  v_mul_f32 v38, v38, v94
  v_mul_f32 v39, v39, v95
  v_mul_f32 v40, v40, v96
  v_mul_f32 v41, v41, v97
  v_mul_f32 v42, v42, v98
  v_mul_f32 v43, v43, v99
  v_mul_f32 v44, v44, v100
  v_mul_f32 v45, v45, v101
  v_mul_f32 v46, v46, v102
  v_mul_f32 v47, v47, v103
  v_cvt_pk_bf16_f32 v64, v32, v33
  v_cvt_pk_bf16_f32 v65, v34, v35
  v_cvt_pk_bf16_f32 v66, v36, v37
  v_cvt_pk_bf16_f32 v67, v38, v39
  v_cvt_pk_bf16_f32 v68, v40, v41
  v_cvt_pk_bf16_f32 v69, v42, v43
  v_cvt_pk_bf16_f32 v70, v44, v45
  v_cvt_pk_bf16_f32 v71, v46, v47
  buffer_store_dwordx4 v[64:67], v15, s[48:51], s87 offen offset:2048 sc1
  buffer_store_dwordx4 v[68:71], v15, s[48:51], s87 offen offset:3072 sc1
Lg1e_56:
  s_waitcnt vmcnt(0)
  s_mov_b64 exec, 1
  s_cmp_lg_u32 s100, 0
  s_cbranch_scc1 Lslow_57
  buffer_store_dwordx2 v[250:251], v253, s[48:51], s88 offen
  s_branch Lpe_58
Lslow_57:
  buffer_store_dwordx2 v[250:251], v253, s[48:51], s88 offen sc1
Lpe_58:
  s_mov_b64 exec, -1
  s_setprio 0
  s_cmp_ge_u32 s3, 4
  s_cbranch_scc1 Lg2_59
  s_add_u32 m0, s29, 65536
  s_add_u32 s37, s24, 157696
  buffer_load_dwordx4 v2, s[68:71], s37 offen lds
  s_add_u32 m0, s29, 66560
  s_add_u32 s37, s24, 164864
  buffer_load_dwordx4 v2, s[68:71], s37 offen lds
  s_add_u32 m0, s29, 67584
  s_add_u32 s37, s24, 172032
  buffer_load_dwordx4 v2, s[68:71], s37 offen lds
  s_add_u32 m0, s29, 68608
  s_add_u32 s37, s24, 179200
  buffer_load_dwordx4 v2, s[68:71], s37 offen lds
  s_add_u32 m0, s29, 69632
  s_add_u32 s37, s24, 186368
  buffer_load_dwordx4 v2, s[68:71], s37 offen lds
  s_add_u32 m0, s29, 70656
  s_add_u32 s37, s24, 193536
  buffer_load_dwordx4 v2, s[68:71], s37 offen lds
Lg2_59:
  v_and_b32 v10, 3, v1
  v_bfe_u32 v3, v1, 2, 1
  v_lshl_add_u32 v10, v3, 5, v10
  v_lshlrev_b32 v10, 3, v10
  buffer_load_dwordx2 v[78:79], v10, s[48:51], s89 offen sc1
  ds_read_b64_tr_b16 v[152:153], v11 offset:49152
  ds_read_b64_tr_b16 v[154:155], v11 offset:50176
  ds_read_b64_tr_b16 v[156:157], v12 offset:49152
  ds_read_b64_tr_b16 v[158:159], v12 offset:50176
  ds_read_b64_tr_b16 v[160:161], v11 offset:51200
  ds_read_b64_tr_b16 v[162:163], v11 offset:52224
  ds_read_b64_tr_b16 v[164:165], v12 offset:51200
  ds_read_b64_tr_b16 v[166:167], v12 offset:52224
  ds_read_b64_tr_b16 v[168:169], v11 offset:53248
  ds_read_b64_tr_b16 v[170:171], v11 offset:54272
  ds_read_b64_tr_b16 v[172:173], v12 offset:53248
  ds_read_b64_tr_b16 v[174:175], v12 offset:54272
  s_xor_b32 s37, s3, 4
  s_mul_i32 s37, s37, 14336
  s_add_u32 s37, s37, 6144
  v_add_u32 v240, s37, v15
  s_xor_b32 s37, s3, 5
  s_mul_i32 s37, s37, 14336
  s_add_u32 s37, s37, 8192
  v_add_u32 v241, s37, v15
  s_xor_b32 s37, s3, 6
  s_mul_i32 s37, s37, 14336
  s_add_u32 s37, s37, 10240
  v_add_u32 v242, s37, v15
  s_xor_b32 s37, s3, 7
  s_mul_i32 s37, s37, 14336
  s_add_u32 s37, s37, 12288
  v_add_u32 v243, s37, v15
  s_xor_b32 s37, s3, 1
  s_mul_i32 s37, s37, 14336
  s_add_u32 s37, s37, 0
  v_add_u32 v6, s37, v15
  s_xor_b32 s37, s3, 2
  s_mul_i32 s37, s37, 14336
  s_add_u32 s37, s37, 2048
  v_add_u32 v7, s37, v15
  s_xor_b32 s37, s3, 3
  s_mul_i32 s37, s37, 14336
  s_add_u32 s37, s37, 4096
  v_add_u32 v8, s37, v15
  s_mul_i32 s37, s3, 14336
  s_add_u32 s37, s37, 0
  v_add_u32 v5, s37, v15
  s_waitcnt vmcnt(1) lgkmcnt(2)
  ds_read_b64_tr_b16 v[176:177], v11 offset:0
  ds_read_b64_tr_b16 v[178:179], v11 offset:1024
  ds_read_b64_tr_b16 v[180:181], v12 offset:0
  ds_read_b64_tr_b16 v[182:183], v12 offset:1024
  ds_read_b64_tr_b16 v[184:185], v11 offset:2048
  ds_read_b64_tr_b16 v[186:187], v11 offset:3072
  ds_read_b64_tr_b16 v[188:189], v12 offset:2048
  ds_read_b64_tr_b16 v[190:191], v12 offset:3072
  ds_read_b64_tr_b16 v[192:193], v11 offset:4096
  ds_read_b64_tr_b16 v[194:195], v11 offset:5120
  ds_read_b64_tr_b16 v[196:197], v12 offset:4096
  ds_read_b64_tr_b16 v[198:199], v12 offset:5120
  s_waitcnt vmcnt(0)
  s_branch Lpc_62
Lpt_60:
  buffer_load_dwordx2 v[78:79], v10, s[48:51], s89 offen sc1
  s_waitcnt vmcnt(0)
Lpc_62:
  v_cmp_ne_u64 vcc, s[38:39], v[78:79]
  s_nop 0
  s_cbranch_vccz Lpd_61
  s_sub_u32 s101, s101, 1
  s_cbranch_scc1 Lpd_61
  s_sleep 1
  s_branch Lpt_60
Lpd_61:
  s_add_u32 s37, s91, 0
  buffer_load_dwordx4 v[80:83], v15, s[48:51], s37 offen offset:0 sc1
  s_add_u32 s37, s91, 0
  buffer_load_dwordx4 v[84:87], v15, s[48:51], s37 offen offset:1024 sc1
  s_add_u32 s37, s91, 0
  buffer_load_dwordx4 v[88:91], v15, s[48:51], s37 offen offset:2048 sc1
  s_add_u32 s37, s91, 0
  buffer_load_dwordx4 v[92:95], v15, s[48:51], s37 offen offset:3072 sc1
  s_add_u32 s37, s91, 4096
  buffer_load_dwordx4 v[96:99], v15, s[48:51], s37 offen offset:0 sc1
  s_add_u32 s37, s91, 4096
  buffer_load_dwordx4 v[100:103], v15, s[48:51], s37 offen offset:1024 sc1
  s_add_u32 s37, s91, 4096
  buffer_load_dwordx4 v[104:107], v15, s[48:51], s37 offen offset:2048 sc1
  s_waitcnt lgkmcnt(0)
  s_waitcnt vmcnt(6)
  v_mfma_f32_32x32x16_bf16 v[48:63], v[200:203], v[80:83], 0
  v_mfma_f32_32x32x16_bf16 v[64:79], v[204:207], v[80:83], 0
  s_add_u32 s37, s26, 4096
  buffer_load_dwordx4 v[108:111], v15, s[48:51], s37 offen offset:3072 sc1
  s_waitcnt vmcnt(6)
  v_mfma_f32_32x32x16_bf16 v[48:63], v[208:211], v[84:87], v[48:63]
  v_mfma_f32_32x32x16_bf16 v[64:79], v[212:215], v[84:87], v[64:79]
  s_add_u32 s37, s26, 8192
  buffer_load_dwordx4 v[112:115], v15, s[48:51], s37 offen offset:0 sc1
  s_waitcnt vmcnt(6)
  v_mfma_f32_32x32x16_bf16 v[48:63], v[216:219], v[88:91], v[48:63]
  v_mfma_f32_32x32x16_bf16 v[64:79], v[220:223], v[88:91], v[64:79]
  s_add_u32 s37, s26, 8192
  buffer_load_dwordx4 v[116:119], v15, s[48:51], s37 offen offset:1024 sc1
  s_waitcnt vmcnt(6)
  v_mfma_f32_32x32x16_bf16 v[48:63], v[224:227], v[92:95], v[48:63]
  v_mfma_f32_32x32x16_bf16 v[64:79], v[228:231], v[92:95], v[64:79]
  s_add_u32 s37, s26, 8192
  buffer_load_dwordx4 v[120:123], v15, s[48:51], s37 offen offset:2048 sc1
  s_waitcnt vmcnt(6)
  v_mfma_f32_32x32x16_bf16 v[48:63], v[232:235], v[96:99], v[48:63]
  v_mfma_f32_32x32x16_bf16 v[64:79], v[236:239], v[96:99], v[64:79]
  s_add_u32 s37, s26, 8192
  buffer_load_dwordx4 v[124:127], v15, s[48:51], s37 offen offset:3072 sc1
  s_waitcnt vmcnt(6)
  v_mfma_f32_32x32x16_bf16 v[48:63], v[128:131], v[100:103], v[48:63]
  v_mfma_f32_32x32x16_bf16 v[64:79], v[132:135], v[100:103], v[64:79]
  s_add_u32 s37, s26, 12288
  buffer_load_dwordx4 v[80:83], v15, s[48:51], s37 offen offset:0 sc1
  s_waitcnt vmcnt(6)
  v_mfma_f32_32x32x16_bf16 v[48:63], v[136:139], v[104:107], v[48:63]
  v_mfma_f32_32x32x16_bf16 v[64:79], v[140:143], v[104:107], v[64:79]
  s_add_u32 s37, s26, 12288
  buffer_load_dwordx4 v[84:87], v15, s[48:51], s37 offen offset:1024 sc1
  s_waitcnt vmcnt(6)
  v_mfma_f32_32x32x16_bf16 v[48:63], v[144:147], v[108:111], v[48:63]
  v_mfma_f32_32x32x16_bf16 v[64:79], v[148:151], v[108:111], v[64:79]
  s_add_u32 s37, s90, 0
  buffer_load_dwordx4 v[88:91], v15, s[48:51], s37 offen offset:0 sc1
  s_waitcnt vmcnt(6)
  v_mfma_f32_32x32x16_bf16 v[48:63], v[152:155], v[112:115], v[48:63]
  v_mfma_f32_32x32x16_bf16 v[64:79], v[156:159], v[112:115], v[64:79]
  s_add_u32 s37, s90, 0
  buffer_load_dwordx4 v[92:95], v15, s[48:51], s37 offen offset:1024 sc1
  s_waitcnt vmcnt(6)
  v_mfma_f32_32x32x16_bf16 v[48:63], v[160:163], v[116:119], v[48:63]
  v_mfma_f32_32x32x16_bf16 v[64:79], v[164:167], v[116:119], v[64:79]
  s_add_u32 s37, s90, 0
  buffer_load_dwordx4 v[96:99], v15, s[48:51], s37 offen offset:2048 sc1
  s_waitcnt vmcnt(6)
  v_mfma_f32_32x32x16_bf16 v[48:63], v[168:171], v[120:123], v[48:63]
  v_mfma_f32_32x32x16_bf16 v[64:79], v[172:175], v[120:123], v[64:79]
  s_add_u32 s37, s90, 0
  buffer_load_dwordx4 v[100:103], v15, s[48:51], s37 offen offset:3072 sc1
  s_waitcnt vmcnt(6)
  v_mfma_f32_32x32x16_bf16 v[48:63], v[176:179], v[124:127], v[48:63]
  v_mfma_f32_32x32x16_bf16 v[64:79], v[180:183], v[124:127], v[64:79]
  s_add_u32 s37, s90, 4096
  buffer_load_dwordx4 v[104:107], v15, s[48:51], s37 offen offset:0 sc1
  s_waitcnt vmcnt(6)
  v_mfma_f32_32x32x16_bf16 v[48:63], v[184:187], v[80:83], v[48:63]
  v_mfma_f32_32x32x16_bf16 v[64:79], v[188:191], v[80:83], v[64:79]
  s_add_u32 s37, s90, 4096
  buffer_load_dwordx4 v[108:111], v15, s[48:51], s37 offen offset:1024 sc1
  s_waitcnt vmcnt(6)
  v_mfma_f32_32x32x16_bf16 v[48:63], v[192:195], v[84:87], v[48:63]
  v_mfma_f32_32x32x16_bf16 v[64:79], v[196:199], v[84:87], v[64:79]
  s_add_u32 s37, s90, 4096
  buffer_load_dwordx4 v[112:115], v15, s[48:51], s37 offen offset:2048 sc1
  s_waitcnt vmcnt(6)
  v_mfma_f32_32x32x16_bf16 v[32:47], v[204:207], v[88:91], 0
  v_mfma_f32_32x32x16_bf16 v[16:31], v[200:203], v[88:91], 0
  s_add_u32 s37, s25, 4096
  buffer_load_dwordx4 v[116:119], v15, s[48:51], s37 offen offset:3072 sc1
  s_barrier
  s_waitcnt vmcnt(6)
  v_mfma_f32_32x32x16_bf16 v[32:47], v[212:215], v[92:95], v[32:47]
  v_mfma_f32_32x32x16_bf16 v[16:31], v[208:211], v[92:95], v[16:31]
  s_add_u32 s37, s25, 8192
  buffer_load_dwordx4 v[120:123], v15, s[48:51], s37 offen offset:0 sc1
  ds_write_b128 v240, v[48:51] offset:0
  ds_write_b128 v240, v[52:55] offset:1024
  s_waitcnt vmcnt(6)
  v_mfma_f32_32x32x16_bf16 v[32:47], v[220:223], v[96:99], v[32:47]
  v_mfma_f32_32x32x16_bf16 v[16:31], v[216:219], v[96:99], v[16:31]
  s_add_u32 s37, s25, 8192
  buffer_load_dwordx4 v[124:127], v15, s[48:51], s37 offen offset:1024 sc1
  ds_write_b128 v241, v[56:59] offset:0
  ds_write_b128 v241, v[60:63] offset:1024
  s_waitcnt vmcnt(6)
  v_mfma_f32_32x32x16_bf16 v[32:47], v[228:231], v[100:103], v[32:47]
  v_mfma_f32_32x32x16_bf16 v[16:31], v[224:227], v[100:103], v[16:31]
  s_add_u32 s37, s25, 8192
  buffer_load_dwordx4 v[80:83], v15, s[48:51], s37 offen offset:2048 sc1
  ds_write_b128 v242, v[64:67] offset:0
  ds_write_b128 v242, v[68:71] offset:1024
  s_waitcnt vmcnt(6)
  v_mfma_f32_32x32x16_bf16 v[32:47], v[236:239], v[104:107], v[32:47]
  v_mfma_f32_32x32x16_bf16 v[16:31], v[232:235], v[104:107], v[16:31]
  s_add_u32 s37, s25, 8192
  buffer_load_dwordx4 v[84:87], v15, s[48:51], s37 offen offset:3072 sc1
  ds_write_b128 v243, v[72:75] offset:0
  ds_write_b128 v243, v[76:79] offset:1024
  s_waitcnt vmcnt(6)
  v_mfma_f32_32x32x16_bf16 v[32:47], v[132:135], v[108:111], v[32:47]
  v_mfma_f32_32x32x16_bf16 v[16:31], v[128:131], v[108:111], v[16:31]
  s_add_u32 s37, s25, 12288
  buffer_load_dwordx4 v[88:91], v15, s[48:51], s37 offen offset:0 sc1
  s_waitcnt vmcnt(6)
  v_mfma_f32_32x32x16_bf16 v[32:47], v[140:143], v[112:115], v[32:47]
  v_mfma_f32_32x32x16_bf16 v[16:31], v[136:139], v[112:115], v[16:31]
  s_add_u32 s37, s25, 12288
  buffer_load_dwordx4 v[92:95], v15, s[48:51], s37 offen offset:1024 sc1
  s_waitcnt vmcnt(6)
  v_mfma_f32_32x32x16_bf16 v[32:47], v[148:151], v[116:119], v[32:47]
  v_mfma_f32_32x32x16_bf16 v[16:31], v[144:147], v[116:119], v[16:31]
  s_waitcnt lgkmcnt(0)
  s_barrier
  ds_read_b128 v[48:51], v5 offset:6144
  ds_read_b128 v[52:55], v5 offset:7168
  ds_read_b128 v[56:59], v5 offset:8192
  ds_read_b128 v[60:63], v5 offset:9216
  ds_read_b128 v[64:67], v5 offset:10240
  ds_read_b128 v[68:71], v5 offset:11264
  ds_read_b128 v[72:75], v5 offset:12288
  ds_read_b128 v[76:79], v5 offset:13312
  s_waitcnt vmcnt(5)
  v_mfma_f32_32x32x16_bf16 v[32:47], v[156:159], v[120:123], v[32:47]
  v_mfma_f32_32x32x16_bf16 v[16:31], v[152:155], v[120:123], v[16:31]
  s_waitcnt vmcnt(4)
  v_mfma_f32_32x32x16_bf16 v[32:47], v[164:167], v[124:127], v[32:47]
  v_mfma_f32_32x32x16_bf16 v[16:31], v[160:163], v[124:127], v[16:31]
  s_waitcnt lgkmcnt(0)
  v_add_f32 v48, v48, v56
  v_add_f32 v64, v64, v72
  v_add_f32 v49, v49, v57
  v_add_f32 v65, v65, v73
  v_add_f32 v50, v50, v58
  v_add_f32 v66, v66, v74
  v_add_f32 v51, v51, v59
  v_add_f32 v67, v67, v75
  v_add_f32 v52, v52, v60
  v_add_f32 v68, v68, v76
  v_add_f32 v53, v53, v61
  v_add_f32 v69, v69, v77
  v_add_f32 v54, v54, v62
  v_add_f32 v70, v70, v78
  v_add_f32 v55, v55, v63
  v_add_f32 v71, v71, v79
  s_waitcnt vmcnt(3)
  v_mfma_f32_32x32x16_bf16 v[32:47], v[172:175], v[80:83], v[32:47]
  v_mfma_f32_32x32x16_bf16 v[16:31], v[168:171], v[80:83], v[16:31]
  v_add_f32 v48, v48, v64
  v_add_f32 v49, v49, v65
  v_add_f32 v50, v50, v66
  v_add_f32 v51, v51, v67
  v_add_f32 v52, v52, v68
  v_add_f32 v53, v53, v69
  v_add_f32 v54, v54, v70
  v_add_f32 v55, v55, v71
  v_lshlrev_b32 v56, 16, v244
  v_and_b32 v57, 0xffff0000, v244
  v_lshlrev_b32 v58, 16, v245
  v_and_b32 v59, 0xffff0000, v245
  v_lshlrev_b32 v60, 16, v246
  v_and_b32 v61, 0xffff0000, v246
  v_lshlrev_b32 v62, 16, v247
  v_and_b32 v63, 0xffff0000, v247
  s_waitcnt vmcnt(2)
  v_mfma_f32_32x32x16_bf16 v[32:47], v[180:183], v[84:87], v[32:47]
  v_mfma_f32_32x32x16_bf16 v[16:31], v[176:179], v[84:87], v[16:31]
  v_add_f32 v48, v48, v56
  v_add_f32 v49, v49, v57
  v_add_f32 v50, v50, v58
  v_add_f32 v51, v51, v59
  v_add_f32 v52, v52, v60
  v_add_f32 v53, v53, v61
  v_add_f32 v54, v54, v62
  v_add_f32 v55, v55, v63
  s_waitcnt vmcnt(1)
  v_mfma_f32_32x32x16_bf16 v[32:47], v[188:191], v[88:91], v[32:47]
  v_mfma_f32_32x32x16_bf16 v[16:31], v[184:187], v[88:91], v[16:31]
  s_waitcnt vmcnt(0)
  v_mfma_f32_32x32x16_bf16 v[32:47], v[196:199], v[92:95], v[32:47]
  v_mfma_f32_32x32x16_bf16 v[16:31], v[192:195], v[92:95], v[16:31]
  s_nop 10
  ds_write_b128 v7, v[32:35] offset:0
  ds_write_b128 v7, v[36:39] offset:1024
  ds_write_b128 v8, v[40:43] offset:0
  ds_write_b128 v8, v[44:47] offset:1024
  ds_write_b128 v6, v[24:27] offset:0
  ds_write_b128 v6, v[28:31] offset:1024
  v_pk_add_f32 v[16:17], v[16:17], v[48:49]
  v_pk_add_f32 v[18:19], v[18:19], v[50:51]
  v_pk_add_f32 v[20:21], v[20:21], v[52:53]
  v_pk_add_f32 v[22:23], v[22:23], v[54:55]
  s_waitcnt lgkmcnt(0)
  s_barrier
  ds_read_b128 v[48:51], v5 offset:0
  ds_read_b128 v[52:55], v5 offset:1024
  ds_read_b128 v[56:59], v5 offset:2048
  ds_read_b128 v[60:63], v5 offset:3072
  ds_read_b128 v[64:67], v5 offset:4096
  ds_read_b128 v[68:71], v5 offset:5120
  s_waitcnt lgkmcnt(5)
  v_pk_add_f32 v[16:17], v[16:17], v[48:49]
  v_pk_add_f32 v[18:19], v[18:19], v[50:51]
  s_waitcnt lgkmcnt(4)
  v_pk_add_f32 v[20:21], v[20:21], v[52:53]
  v_pk_add_f32 v[22:23], v[22:23], v[54:55]
  s_waitcnt lgkmcnt(3)
  v_pk_add_f32 v[16:17], v[16:17], v[56:57]
  v_pk_add_f32 v[18:19], v[18:19], v[58:59]
  s_waitcnt lgkmcnt(2)
  v_pk_add_f32 v[20:21], v[20:21], v[60:61]
  v_pk_add_f32 v[22:23], v[22:23], v[62:63]
  s_waitcnt lgkmcnt(1)
  v_pk_add_f32 v[16:17], v[16:17], v[64:65]
  v_pk_add_f32 v[18:19], v[18:19], v[66:67]
  s_waitcnt lgkmcnt(0)
  v_pk_add_f32 v[20:21], v[20:21], v[68:69]
  v_pk_add_f32 v[22:23], v[22:23], v[70:71]
  v_cvt_pk_bf16_f32 v80, v16, v17
  v_cvt_pk_bf16_f32 v81, v18, v19
  v_cvt_pk_bf16_f32 v82, v20, v21
  v_cvt_pk_bf16_f32 v83, v22, v23
  s_nop 0
  v_permlane32_swap_b32 v80, v82
  v_permlane32_swap_b32 v81, v83
  buffer_store_dwordx4 v[80:83], v4, s[76:79], s22 offen
  s_or_b32 s37, s2, s3
  s_cbranch_scc1 L_fin
  s_mov_b64 exec, 1
  buffer_store_dwordx2 v[250:251], v253, s[52:55], 0 offen sc1
  s_mov_b64 exec, -1
L_fin:
L_end:
  s_endpgm
L_code_end:
.p2align 7
.type L_table,@object
L_table:
.long 1032192,1032192,4096,1016832,0,2097152,2097152,1048576,1048576,524288,1015808,0,0,0,0,0,524288,1015808,786432,1017856,786432,1017856,1021952,1048576,1019904,1019904,1048576,1163264,16384,520192,1013760,0
.long 1032208,1032704,4096,1016840,2048,2129920,2097280,1048704,1050624,557056,1015936,50176,28672,200704,32,0,532480,1015840,787456,1017864,815104,1018112,1022464,1163264,1020160,1019928,1062912,1177600,16384,522240,1013760,0
.long 1032224,1033216,4096,1016848,4096,2162688,2097408,1048832,1052672,589824,1016064,100352,57344,401408,64,0,540672,1015872,788480,1017872,843776,1018368,1022976,1277952,1020416,1019960,1077248,1191936,16384,524288,1013760,0
.long 1032240,1033728,4096,1016856,6144,2195456,2097536,1048960,1054720,622592,1016192,150528,86016,602112,96,0,548864,1015904,789504,1017880,872448,1018624,1023488,1392640,1020672,1019984,1091584,1206272,16384,526336,1013760,0
.long 1032256,1032192,4096,1016864,8192,2228224,2097664,1049088,1056768,526336,1015816,200704,114688,802816,28672,0,557056,1015936,815104,1018112,901120,1018880,1024000,1507328,1020928,1020016,1220608,1105920,16384,528384,1013760,0
.long 1032272,1032704,4096,1016872,10240,2260992,2097792,1049216,1058816,559104,1015944,250880,143360,1003520,28704,0,565248,1015968,816128,1018120,929792,1019136,1024512,1622016,1021184,1020040,1234944,1120256,16384,530432,1013760,0
.long 1032288,1033216,4096,1016880,12288,2293760,2097920,1049344,1060864,591872,1016072,301056,172032,1204224,28736,0,573440,1016000,817152,1018128,958464,1019392,1025024,1736704,1021440,1020072,1249280,1134592,16384,532480,1013760,0
.long 1032304,1033728,4096,1016888,14336,2326528,2098048,1049472,1062912,624640,1016200,351232,200704,1404928,28768,0,581632,1016032,818176,1018136,987136,1019648,1025536,1851392,1021696,1020096,1263616,1148928,16384,534528,1013760,0
.long 1032320,1032192,4112,1016896,16384,2359296,2359296,1064960,1064960,528384,1015824,128,128,802944,128,128,524288,1015808,790528,1017888,786432,1017856,1021952,1052672,1019912,1020016,1105920,1220608,16896,536576,1014400,0
.long 1032336,1032704,4112,1016904,18432,2392064,2359424,1065088,1067008,561152,1015952,50304,28800,1003648,160,128,532480,1015840,791552,1017896,815104,1018112,1022464,1167360,1020168,1020040,1120256,1234944,16896,538624,1014400,0
.long 1032352,1033216,4112,1016912,20480,2424832,2359552,1065216,1069056,593920,1016080,100480,57472,1204352,192,128,540672,1015872,792576,1017904,843776,1018368,1022976,1282048,1020424,1020072,1134592,1249280,16896,540672,1014400,0
.long 1032368,1033728,4112,1016920,22528,2457600,2359680,1065344,1071104,626688,1016208,150656,86144,1405056,224,128,548864,1015904,793600,1017912,872448,1018624,1023488,1396736,1020680,1020096,1148928,1263616,16896,542720,1014400,0
.long 1032384,1032192,4112,1016928,24576,2490368,2359808,1065472,1073152,530432,1015832,200832,114816,128,28800,128,557056,1015936,819200,1018144,901120,1018880,1024000,1511424,1020936,1019904,1163264,1048576,16896,544768,1014400,0
.long 1032400,1032704,4112,1016936,26624,2523136,2359936,1065600,1075200,563200,1015960,251008,143488,200832,28832,128,565248,1015968,820224,1018152,929792,1019136,1024512,1626112,1021192,1019928,1177600,1062912,16896,546816,1014400,0
.long 1032416,1033216,4112,1016944,28672,2555904,2360064,1065728,1077248,595968,1016088,301184,172160,401536,28864,128,573440,1016000,821248,1018160,958464,1019392,1025024,1740800,1021448,1019960,1191936,1077248,16896,548864,1014400,0
.long 1032432,1033728,4112,1016952,30720,2588672,2360192,1065856,1079296,628736,1016216,351360,200832,602240,28896,128,581632,1016032,822272,1018168,987136,1019648,1025536,1855488,1021704,1019984,1206272,1091584,16896,550912,1014400,0
.long 1032448,1032192,4128,1016960,32768,2621440,2621440,1081344,1081344,532480,1015840,256,256,100608,256,256,524288,1015808,794624,1017920,786432,1017856,1021952,1056768,1019920,1019904,1055744,1170432,17408,552960,1015040,4294967282
.long 1032464,1032704,4128,1016968,34816,2654208,2621568,1081472,1083392,565248,1015968,50432,28928,301312,288,256,532480,1015840,795648,1017928,815104,1018112,1022464,1171456,1020176,1019928,1070080,1184768,17408,555008,1015040,4294967282
.long 1032480,1033216,4128,1016976,36864,2686976,2621696,1081600,1085440,598016,1016096,100608,57600,502016,320,256,540672,1015872,796672,1017936,843776,1018368,1022976,1286144,1020432,1019960,1084416,1199104,17408,557056,1015040,4294967282
.long 1032496,1033728,4128,1016984,38912,2719744,2621824,1081728,1087488,630784,1016224,150784,86272,702720,352,256,548864,1015904,797696,1017944,872448,1018624,1023488,1400832,1020688,1019984,1098752,1213440,17408,559104,1015040,4294967282
.long 1032512,1032192,4128,1016992,40960,2752512,2621952,1081856,1089536,534528,1015848,200960,114944,903424,28928,256,557056,1015936,823296,1018176,901120,1018880,1024000,1515520,1020944,1020016,1227776,1113088,17408,561152,1015040,4294967282
.long 1032528,1032704,4128,1017000,43008,2785280,2622080,1081984,1091584,567296,1015976,251136,143616,1104128,28960,256,565248,1015968,824320,1018184,929792,1019136,1024512,1630208,1021200,1020040,1242112,1127424,17408,563200,1015040,4294967282
.long 1032544,1033216,4128,1017008,45056,2818048,2622208,1082112,1093632,600064,1016104,301312,172288,1304832,28992,256,573440,1016000,825344,1018192,958464,1019392,1025024,1744896,1021456,1020072,1256448,1141760,17408,565248,1015040,4294967282
.long 1032560,1033728,4128,1017016,47104,2850816,2622336,1082240,1095680,632832,1016232,351488,200960,1505536,29024,256,581632,1016032,826368,1018200,987136,1019648,1025536,1859584,1021712,1020096,1270784,1156096,17408,567296,1015040,4294967282
.long 1032576,1032192,4144,1017024,49152,2883584,2883584,1097728,1097728,536576,1015856,384,0,903552,384,384,524288,1015808,798720,1017952,786432,1017856,1021952,1060864,1019928,1020016,1113088,1227776,16384,569344,1015680,4294967282
.long 1032592,1032704,4144,1017032,51200,2916352,2883712,1097856,1099776,569344,1015984,50560,28672,1104256,416,384,532480,1015840,799744,1017960,793600,1017912,1021952,1175552,1020184,1020040,1127424,1242112,16384,571392,1015680,4294967282
.long 1032608,1033216,4144,1017040,53248,2949120,2883840,1097984,1101824,602112,1016112,100736,57344,1304960,448,384,540672,1015872,800768,1017968,800768,1017968,1021952,1290240,1020440,1020072,1141760,1256448,16384,573440,1015680,4294967282
.long 1032624,1033728,4144,1017048,55296,2981888,2883968,1098112,1103872,634880,1016240,150912,86016,1505664,480,384,548864,1015904,801792,1017976,807936,1018024,1021952,1404928,1020696,1020096,1156096,1270784,16384,575488,1015680,4294967282
.long 1032640,1032192,4144,1017056,57344,3014656,2884096,1098240,1105920,538624,1015864,201088,114688,100736,29056,384,557056,1015936,827392,1018208,815104,1018112,1022464,1519616,1020952,1019904,1170432,1055744,16384,577536,1015680,4294967282
.long 1032656,1032704,4144,1017064,59392,3047424,2884224,1098368,1107968,571392,1015992,251264,143360,301440,29088,384,565248,1015968,828416,1018216,822272,1018168,1022464,1634304,1021208,1019928,1184768,1070080,16384,579584,1015680,4294967282
.long 1032672,1033216,4144,1017072,61440,3080192,2884352,1098496,1110016,604160,1016120,301440,172032,502144,29120,384,573440,1016000,829440,1018224,829440,1018224,1022464,1748992,1021464,1019960,1199104,1084416,16384,581632,1015680,4294967282
.long 1032688,1033728,4144,1017080,63488,3112960,2884480,1098624,1112064,636928,1016248,351616,200704,702848,29152,384,581632,1016032,830464,1018232,836608,1018280,1022464,1863680,1021720,1019984,1213440,1098752,16384,583680,1015680,4294967282
.long 1032704,1032192,4160,1017088,65536,3145728,3145728,1114112,1114112,540672,1015872,384,384,903552,384,384,524288,1015808,798720,1017952,786432,1017856,1021952,1060864,1019928,1020016,1113088,1227776,17920,585728,1016320,4294967282
.long 1032720,1032704,4160,1017096,67584,3178496,3145856,1114240,1116160,573440,1016000,50560,29056,1104256,416,384,532480,1015840,799744,1017960,815104,1018112,1022464,1175552,1020184,1020040,1127424,1242112,17920,587776,1016320,4294967282
.long 1032736,1033216,4160,1017104,69632,3211264,3145984,1114368,1118208,606208,1016128,100736,57728,1304960,448,384,540672,1015872,800768,1017968,843776,1018368,1022976,1290240,1020440,1020072,1141760,1256448,17920,589824,1016320,4294967282
.long 1032752,1033728,4160,1017112,71680,3244032,3146112,1114496,1120256,638976,1016256,150912,86400,1505664,480,384,548864,1015904,801792,1017976,872448,1018624,1023488,1404928,1020696,1020096,1156096,1270784,17920,591872,1016320,4294967282
.long 1032768,1032192,4160,1017120,73728,3276800,3146240,1114624,1122304,542720,1015880,201088,115072,100736,29056,384,557056,1015936,827392,1018208,901120,1018880,1024000,1519616,1020952,1019904,1170432,1055744,17920,593920,1016320,4294967282
.long 1032784,1032704,4160,1017128,75776,3309568,3146368,1114752,1124352,575488,1016008,251264,143744,301440,29088,384,565248,1015968,828416,1018216,929792,1019136,1024512,1634304,1021208,1019928,1184768,1070080,17920,595968,1016320,4294967282
.long 1032800,1033216,4160,1017136,77824,3342336,3146496,1114880,1126400,608256,1016136,301440,172416,502144,29120,384,573440,1016000,829440,1018224,958464,1019392,1025024,1748992,1021464,1019960,1199104,1084416,17920,598016,1016320,4294967282
.long 1032816,1033728,4160,1017144,79872,3375104,3146624,1115008,1128448,641024,1016264,351616,201088,702848,29152,384,581632,1016032,830464,1018232,987136,1019648,1025536,1863680,1021720,1019984,1213440,1098752,17920,600064,1016320,4294967282
.long 1032832,1032192,4176,1017152,81920,3407872,3407872,1130496,1130496,544768,1015888,512,512,512,512,512,524288,1015808,802816,1017984,786432,1017856,1021952,1064960,1019936,1019904,1048576,1163264,18432,602112,1016960,0
.long 1032848,1032704,4176,1017160,83968,3440640,3408000,1130624,1132544,577536,1016016,50688,29184,201216,544,512,532480,1015840,803840,1017992,815104,1018112,1022464,1179648,1020192,1019928,1062912,1177600,18432,604160,1016960,0
.long 1032864,1033216,4176,1017168,86016,3473408,3408128,1130752,1134592,610304,1016144,100864,57856,401920,576,512,540672,1015872,804864,1018000,843776,1018368,1022976,1294336,1020448,1019960,1077248,1191936,18432,606208,1016960,0
.long 1032880,1033728,4176,1017176,88064,3506176,3408256,1130880,1136640,643072,1016272,151040,86528,602624,608,512,548864,1015904,805888,1018008,872448,1018624,1023488,1409024,1020704,1019984,1091584,1206272,18432,608256,1016960,0
.long 1032896,1032192,4176,1017184,90112,3538944,3408384,1131008,1138688,546816,1015896,201216,115200,803328,29184,512,557056,1015936,831488,1018240,901120,1018880,1024000,1523712,1020960,1020016,1220608,1105920,18432,610304,1016960,0
.long 1032912,1032704,4176,1017192,92160,3571712,3408512,1131136,1140736,579584,1016024,251392,143872,1004032,29216,512,565248,1015968,832512,1018248,929792,1019136,1024512,1638400,1021216,1020040,1234944,1120256,18432,612352,1016960,0
.long 1032928,1033216,4176,1017200,94208,3604480,3408640,1131264,1142784,612352,1016152,301568,172544,1204736,29248,512,573440,1016000,833536,1018256,958464,1019392,1025024,1753088,1021472,1020072,1249280,1134592,18432,614400,1016960,0
.long 1032944,1033728,4176,1017208,96256,3637248,3408768,1131392,1144832,645120,1016280,351744,201216,1405440,29280,512,581632,1016032,834560,1018264,987136,1019648,1025536,1867776,1021728,1020096,1263616,1148928,18432,616448,1016960,0
.long 1032960,1032192,4192,1017216,98304,3670016,3670016,1146880,1146880,548864,1015904,640,640,803456,640,640,524288,1015808,806912,1018016,786432,1017856,1021952,1069056,1019944,1020016,1105920,1220608,18944,618496,1017600,0
.long 1032976,1032704,4192,1017224,100352,3702784,3670144,1147008,1148928,581632,1016032,50816,29312,1004160,672,640,532480,1015840,807936,1018024,815104,1018112,1022464,1183744,1020200,1020040,1120256,1234944,18944,620544,1017600,0
.long 1032992,1033216,4192,1017232,102400,3735552,3670272,1147136,1150976,614400,1016160,100992,57984,1204864,704,640,540672,1015872,808960,1018032,843776,1018368,1022976,1298432,1020456,1020072,1134592,1249280,18944,622592,1017600,0
.long 1033008,1033728,4192,1017240,104448,3768320,3670400,1147264,1153024,647168,1016288,151168,86656,1405568,736,640,548864,1015904,809984,1018040,872448,1018624,1023488,1413120,1020712,1020096,1148928,1263616,18944,624640,1017600,0
.long 1033024,1032192,4192,1017248,106496,3801088,3670528,1147392,1155072,550912,1015912,201344,115328,640,29312,640,557056,1015936,835584,1018272,901120,1018880,1024000,1527808,1020968,1019904,1163264,1048576,18944,626688,1017600,0
.long 1033040,1032704,4192,1017256,108544,3833856,3670656,1147520,1157120,583680,1016040,251520,144000,201344,29344,640,565248,1015968,836608,1018280,929792,1019136,1024512,1642496,1021224,1019928,1177600,1062912,18944,628736,1017600,0
.long 1033056,1033216,4192,1017264,110592,3866624,3670784,1147648,1159168,616448,1016168,301696,172672,402048,29376,640,573440,1016000,837632,1018288,958464,1019392,1025024,1757184,1021480,1019960,1191936,1077248,18944,630784,1017600,0
.long 1033072,1033728,4192,1017272,112640,3899392,3670912,1147776,1161216,649216,1016296,351872,201344,602752,29408,640,581632,1016032,838656,1018296,987136,1019648,1025536,1871872,1021736,1019984,1206272,1091584,18944,632832,1017600,0
.long 1033088,1032192,4208,1017280,114688,3932160,3932160,1163264,1163264,552960,1015920,768,128,101120,768,768,524288,1015808,811008,1018048,843776,1018368,1022976,1073152,1019952,1019904,1055744,1170432,16896,634880,1018240,4294967282
.long 1033104,1032704,4208,1017288,116736,3964928,3932288,1163392,1165312,585728,1016048,50944,28800,301824,800,768,532480,1015840,812032,1018056,850944,1018424,1022976,1187840,1020208,1019928,1070080,1184768,16896,636928,1018240,4294967282
.long 1033120,1033216,4208,1017296,118784,3997696,3932416,1163520,1167360,618496,1016176,101120,57472,502528,832,768,540672,1015872,813056,1018064,858112,1018480,1022976,1302528,1020464,1019960,1084416,1199104,16896,638976,1018240,4294967282
.long 1033136,1033728,4208,1017304,120832,4030464,3932544,1163648,1169408,651264,1016304,151296,86144,703232,864,768,548864,1015904,814080,1018072,865280,1018536,1022976,1417216,1020720,1019984,1098752,1213440,16896,641024,1018240,4294967282
.long 1033152,1032192,4208,1017312,122880,4063232,3932672,1163776,1171456,555008,1015928,201472,114816,903936,29440,768,557056,1015936,839680,1018304,872448,1018624,1023488,1531904,1020976,1020016,1227776,1113088,16896,643072,1018240,4294967282
.long 1033168,1032704,4208,1017320,124928,4096000,3932800,1163904,1173504,587776,1016056,251648,143488,1104640,29472,768,565248,1015968,840704,1018312,879616,1018680,1023488,1646592,1021232,1020040,1242112,1127424,16896,645120,1018240,4294967282
.long 1033184,1033216,4208,1017328,126976,4128768,3932928,1164032,1175552,620544,1016184,301824,172160,1305344,29504,768,573440,1016000,841728,1018320,886784,1018736,1023488,1761280,1021488,1020072,1256448,1141760,16896,647168,1018240,4294967282
.long 1033200,1033728,4208,1017336,129024,4161536,3933056,1164160,1177600,653312,1016312,352000,200832,1506048,29536,768,581632,1016032,842752,1018328,893952,1018792,1023488,1875968,1021744,1020096,1270784,1156096,16896,649216,1018240,4294967282
.long 1034240,1034240,4224,1017344,131072,2098176,2113536,1049600,1048576,655360,1016320,768,768,101120,768,768,524288,1015808,811008,1018048,786432,1017856,1021952,1073152,1019952,1019904,1055744,1170432,19456,651264,1018880,4294967282
.long 1034256,1034752,4224,1017352,133120,2130944,2113664,1049728,1050624,688128,1016448,50944,29440,301824,800,768,532480,1015840,812032,1018056,815104,1018112,1022464,1187840,1020208,1019928,1070080,1184768,19456,653312,1018880,4294967282
.long 1034272,1035264,4224,1017360,135168,2163712,2113792,1049856,1052672,720896,1016576,101120,58112,502528,832,768,540672,1015872,813056,1018064,843776,1018368,1022976,1302528,1020464,1019960,1084416,1199104,19456,655360,1018880,4294967282
.long 1034288,1035776,4224,1017368,137216,2196480,2113920,1049984,1054720,753664,1016704,151296,86784,703232,864,768,548864,1015904,814080,1018072,872448,1018624,1023488,1417216,1020720,1019984,1098752,1213440,19456,657408,1018880,4294967282
.long 1034304,1034240,4224,1017376,139264,2229248,2114048,1050112,1056768,657408,1016328,201472,115456,903936,29440,768,557056,1015936,839680,1018304,901120,1018880,1024000,1531904,1020976,1020016,1227776,1113088,19456,659456,1018880,4294967282
.long 1034320,1034752,4224,1017384,141312,2262016,2114176,1050240,1058816,690176,1016456,251648,144128,1104640,29472,768,565248,1015968,840704,1018312,929792,1019136,1024512,1646592,1021232,1020040,1242112,1127424,19456,661504,1018880,4294967282
.long 1034336,1035264,4224,1017392,143360,2294784,2114304,1050368,1060864,722944,1016584,301824,172800,1305344,29504,768,573440,1016000,841728,1018320,958464,1019392,1025024,1761280,1021488,1020072,1256448,1141760,19456,663552,1018880,4294967282
.long 1034352,1035776,4224,1017400,145408,2327552,2114432,1050496,1062912,755712,1016712,352000,201472,1506048,29536,768,581632,1016032,842752,1018328,987136,1019648,1025536,1875968,1021744,1020096,1270784,1156096,19456,665600,1018880,4294967282
.long 1034368,1034240,4240,1017408,147456,2360320,2375680,1065984,1064960,659456,1016336,0,896,802816,57344,896,589824,1016064,843776,1018368,786432,1017856,1021952,1077248,1019960,1020528,1335296,1449984,19968,667648,1019520,0
.long 1034384,1034752,4240,1017416,149504,2393088,2375808,1066112,1067008,692224,1016464,50176,29568,1003520,57376,896,598016,1016096,844800,1018376,815104,1018112,1022464,1191936,1020216,1020552,1349632,1464320,19968,669696,1019520,0
.long 1034400,1035264,4240,1017424,151552,2425856,2375936,1066240,1069056,724992,1016592,100352,58240,1204224,57408,896,606208,1016128,845824,1018384,843776,1018368,1022976,1306624,1020472,1020584,1363968,1478656,19968,671744,1019520,0
.long 1034416,1035776,4240,1017432,153600,2458624,2376064,1066368,1071104,757760,1016720,150528,86912,1404928,57440,896,614400,1016160,846848,1018392,872448,1018624,1023488,1421312,1020728,1020608,1378304,1492992,19968,673792,1019520,0
.long 1034432,1034240,4240,1017440,155648,2491392,2376192,1066496,1073152,661504,1016344,200704,115584,0,86016,896,622592,1016192,872448,1018624,901120,1018880,1024000,1536000,1020984,1020416,1392640,1277952,19968,675840,1019520,0
.long 1034448,1034752,4240,1017448,157696,2524160,2376320,1066624,1075200,694272,1016472,250880,144256,200704,86048,896,630784,1016224,873472,1018632,929792,1019136,1024512,1650688,1021240,1020440,1406976,1292288,19968,677888,1019520,0
.long 1034464,1035264,4240,1017456,159744,2556928,2376448,1066752,1077248,727040,1016600,301056,172928,401408,86080,896,638976,1016256,874496,1018640,958464,1019392,1025024,1765376,1021496,1020472,1421312,1306624,19968,679936,1019520,0
.long 1034480,1035776,4240,1017464,161792,2589696,2376576,1066880,1079296,759808,1016728,351232,201600,602112,86112,896,647168,1016288,875520,1018648,987136,1019648,1025536,1880064,1021752,1020496,1435648,1320960,19968,681984,1019520,0
.long 1034496,1034240,4256,1017472,163840,2622464,2637824,1082368,1081344,663552,1016352,128,1024,100480,57472,1024,589824,1016064,847872,1018400,786432,1017856,1021952,1081344,1019968,1020416,1285120,1399808,20480,684032,1020160,4294967282
.long 1034512,1034752,4256,1017480,165888,2655232,2637952,1082496,1083392,696320,1016480,50304,29696,301184,57504,1024,598016,1016096,848896,1018408,815104,1018112,1022464,1196032,1020224,1020440,1299456,1414144,20480,686080,1020160,4294967282
.long 1034528,1035264,4256,1017488,167936,2688000,2638080,1082624,1085440,729088,1016608,100480,58368,501888,57536,1024,606208,1016128,849920,1018416,843776,1018368,1022976,1310720,1020480,1020472,1313792,1428480,20480,688128,1020160,4294967282
.long 1034544,1035776,4256,1017496,169984,2720768,2638208,1082752,1087488,761856,1016736,150656,87040,702592,57568,1024,614400,1016160,850944,1018424,872448,1018624,1023488,1425408,1020736,1020496,1328128,1442816,20480,690176,1020160,4294967282
.long 1034560,1034240,4256,1017504,172032,2753536,2638336,1082880,1089536,665600,1016360,200832,115712,903296,86144,1024,622592,1016192,876544,1018656,901120,1018880,1024000,1540096,1020992,1020528,1457152,1342464,20480,692224,1020160,4294967282
.long 1034576,1034752,4256,1017512,174080,2786304,2638464,1083008,1091584,698368,1016488,251008,144384,1104000,86176,1024,630784,1016224,877568,1018664,929792,1019136,1024512,1654784,1021248,1020552,1471488,1356800,20480,694272,1020160,4294967282
.long 1034592,1035264,4256,1017520,176128,2819072,2638592,1083136,1093632,731136,1016616,301184,173056,1304704,86208,1024,638976,1016256,878592,1018672,958464,1019392,1025024,1769472,1021504,1020584,1485824,1371136,20480,696320,1020160,4294967282
.long 1034608,1035776,4256,1017528,178176,2851840,2638720,1083264,1095680,763904,1016744,351360,201728,1505408,86240,1024,647168,1016288,879616,1018680,987136,1019648,1025536,1884160,1021760,1020608,1500160,1385472,20480,698368,1020160,4294967282
.long 1034624,1034240,4272,1017536,180224,2884608,2899968,1098752,1097728,667648,1016368,256,256,903424,57600,1152,589824,1016064,851968,1018432,901120,1018880,1024000,1085440,1019976,1020528,1342464,1457152,17408,700416,1020800,4294967282
.long 1034640,1034752,4272,1017544,182272,2917376,2900096,1098880,1099776,700416,1016496,50432,28928,1104128,57632,1152,598016,1016096,852992,1018440,908288,1018936,1024000,1200128,1020232,1020552,1356800,1471488,17408,702464,1020800,4294967282
.long 1034656,1035264,4272,1017552,184320,2950144,2900224,1099008,1101824,733184,1016624,100608,57600,1304832,57664,1152,606208,1016128,854016,1018448,915456,1018992,1024000,1314816,1020488,1020584,1371136,1485824,17408,704512,1020800,4294967282
.long 1034672,1035776,4272,1017560,186368,2982912,2900352,1099136,1103872,765952,1016752,150784,86272,1505536,57696,1152,614400,1016160,855040,1018456,922624,1019048,1024000,1429504,1020744,1020608,1385472,1500160,17408,706560,1020800,4294967282
.long 1034688,1034240,4272,1017568,188416,3015680,2900480,1099264,1105920,669696,1016376,200960,114944,100608,86272,1152,622592,1016192,880640,1018688,929792,1019136,1024512,1544192,1021000,1020416,1399808,1285120,17408,708608,1020800,4294967282
.long 1034704,1034752,4272,1017576,190464,3048448,2900608,1099392,1107968,702464,1016504,251136,143616,301312,86304,1152,630784,1016224,881664,1018696,936960,1019192,1024512,1658880,1021256,1020440,1414144,1299456,17408,710656,1020800,4294967282
.long 1034720,1035264,4272,1017584,192512,3081216,2900736,1099520,1110016,735232,1016632,301312,172288,502016,86336,1152,638976,1016256,882688,1018704,944128,1019248,1024512,1773568,1021512,1020472,1428480,1313792,17408,712704,1020800,4294967282
.long 1034736,1035776,4272,1017592,194560,3113984,2900864,1099648,1112064,768000,1016760,351488,200960,702720,86368,1152,647168,1016288,883712,1018712,951296,1019304,1024512,1888256,1021768,1020496,1442816,1328128,17408,714752,1020800,4294967282
.long 1034752,1034240,4288,1017600,196608,3146752,3162112,1115136,1114112,671744,1016384,256,1152,903424,57600,1152,589824,1016064,851968,1018432,786432,1017856,1021952,1085440,1019976,1020528,1342464,1457152,20992,716800,1021440,4294967282
.long 1034768,1034752,4288,1017608,198656,3179520,3162240,1115264,1116160,704512,1016512,50432,29824,1104128,57632,1152,598016,1016096,852992,1018440,815104,1018112,1022464,1200128,1020232,1020552,1356800,1471488,20992,718848,1021440,4294967282
.long 1034784,1035264,4288,1017616,200704,3212288,3162368,1115392,1118208,737280,1016640,100608,58496,1304832,57664,1152,606208,1016128,854016,1018448,843776,1018368,1022976,1314816,1020488,1020584,1371136,1485824,20992,720896,1021440,4294967282
.long 1034800,1035776,4288,1017624,202752,3245056,3162496,1115520,1120256,770048,1016768,150784,87168,1505536,57696,1152,614400,1016160,855040,1018456,872448,1018624,1023488,1429504,1020744,1020608,1385472,1500160,20992,722944,1021440,4294967282
.long 1034816,1034240,4288,1017632,204800,3277824,3162624,1115648,1122304,673792,1016392,200960,115840,100608,86272,1152,622592,1016192,880640,1018688,901120,1018880,1024000,1544192,1021000,1020416,1399808,1285120,20992,724992,1021440,4294967282
.long 1034832,1034752,4288,1017640,206848,3310592,3162752,1115776,1124352,706560,1016520,251136,144512,301312,86304,1152,630784,1016224,881664,1018696,929792,1019136,1024512,1658880,1021256,1020440,1414144,1299456,20992,727040,1021440,4294967282
.long 1034848,1035264,4288,1017648,208896,3343360,3162880,1115904,1126400,739328,1016648,301312,173184,502016,86336,1152,638976,1016256,882688,1018704,958464,1019392,1025024,1773568,1021512,1020472,1428480,1313792,20992,729088,1021440,4294967282
.long 1034864,1035776,4288,1017656,210944,3376128,3163008,1116032,1128448,772096,1016776,351488,201856,702720,86368,1152,647168,1016288,883712,1018712,987136,1019648,1025536,1888256,1021768,1020496,1442816,1328128,20992,731136,1021440,4294967282
.long 1034880,1034240,4304,1017664,212992,3408896,3424256,1131520,1130496,675840,1016400,384,1280,384,57728,1280,589824,1016064,856064,1018464,786432,1017856,1021952,1089536,1019984,1020416,1277952,1392640,21504,733184,1022080,0
.long 1034896,1034752,4304,1017672,215040,3441664,3424384,1131648,1132544,708608,1016528,50560,29952,201088,57760,1280,598016,1016096,857088,1018472,815104,1018112,1022464,1204224,1020240,1020440,1292288,1406976,21504,735232,1022080,0
.long 1034912,1035264,4304,1017680,217088,3474432,3424512,1131776,1134592,741376,1016656,100736,58624,401792,57792,1280,606208,1016128,858112,1018480,843776,1018368,1022976,1318912,1020496,1020472,1306624,1421312,21504,737280,1022080,0
.long 1034928,1035776,4304,1017688,219136,3507200,3424640,1131904,1136640,774144,1016784,150912,87296,602496,57824,1280,614400,1016160,859136,1018488,872448,1018624,1023488,1433600,1020752,1020496,1320960,1435648,21504,739328,1022080,0
.long 1034944,1034240,4304,1017696,221184,3539968,3424768,1132032,1138688,677888,1016408,201088,115968,803200,86400,1280,622592,1016192,884736,1018720,901120,1018880,1024000,1548288,1021008,1020528,1449984,1335296,21504,741376,1022080,0
.long 1034960,1034752,4304,1017704,223232,3572736,3424896,1132160,1140736,710656,1016536,251264,144640,1003904,86432,1280,630784,1016224,885760,1018728,929792,1019136,1024512,1662976,1021264,1020552,1464320,1349632,21504,743424,1022080,0
.long 1034976,1035264,4304,1017712,225280,3605504,3425024,1132288,1142784,743424,1016664,301440,173312,1204608,86464,1280,638976,1016256,886784,1018736,958464,1019392,1025024,1777664,1021520,1020584,1478656,1363968,21504,745472,1022080,0
.long 1034992,1035776,4304,1017720,227328,3638272,3425152,1132416,1144832,776192,1016792,351616,201984,1405312,86496,1280,647168,1016288,887808,1018744,987136,1019648,1025536,1892352,1021776,1020608,1492992,1378304,21504,747520,1022080,0
.long 1035008,1034240,4320,1017728,229376,3671040,3686400,1147904,1146880,679936,1016416,512,1408,803328,57856,1408,589824,1016064,860160,1018496,786432,1017856,1021952,1093632,1019992,1020528,1335296,1449984,22016,749568,1022720,0
.long 1035024,1034752,4320,1017736,231424,3703808,3686528,1148032,1148928,712704,1016544,50688,30080,1004032,57888,1408,598016,1016096,861184,1018504,815104,1018112,1022464,1208320,1020248,1020552,1349632,1464320,22016,751616,1022720,0
.long 1035040,1035264,4320,1017744,233472,3736576,3686656,1148160,1150976,745472,1016672,100864,58752,1204736,57920,1408,606208,1016128,862208,1018512,843776,1018368,1022976,1323008,1020504,1020584,1363968,1478656,22016,753664,1022720,0
.long 1035056,1035776,4320,1017752,235520,3769344,3686784,1148288,1153024,778240,1016800,151040,87424,1405440,57952,1408,614400,1016160,863232,1018520,872448,1018624,1023488,1437696,1020760,1020608,1378304,1492992,22016,755712,1022720,0
.long 1035072,1034240,4320,1017760,237568,3802112,3686912,1148416,1155072,681984,1016424,201216,116096,512,86528,1408,622592,1016192,888832,1018752,901120,1018880,1024000,1552384,1021016,1020416,1392640,1277952,22016,757760,1022720,0
.long 1035088,1034752,4320,1017768,239616,3834880,3687040,1148544,1157120,714752,1016552,251392,144768,201216,86560,1408,630784,1016224,889856,1018760,929792,1019136,1024512,1667072,1021272,1020440,1406976,1292288,22016,759808,1022720,0
.long 1035104,1035264,4320,1017776,241664,3867648,3687168,1148672,1159168,747520,1016680,301568,173440,401920,86592,1408,638976,1016256,890880,1018768,958464,1019392,1025024,1781760,1021528,1020472,1421312,1306624,22016,761856,1022720,0
.long 1035120,1035776,4320,1017784,243712,3900416,3687296,1148800,1161216,780288,1016808,351744,202112,602624,86624,1408,647168,1016288,891904,1018776,987136,1019648,1025536,1896448,1021784,1020496,1435648,1320960,22016,763904,1022720,0
.long 1035136,1034240,4336,1017792,245760,3933184,3948544,1164288,1163264,684032,1016432,640,384,100992,57984,1536,589824,1016064,864256,1018528,958464,1019392,1025024,1097728,1020000,1020416,1285120,1399808,17920,765952,1023360,4294967282
.long 1035152,1034752,4336,1017800,247808,3965952,3948672,1164416,1165312,716800,1016560,50816,29056,301696,58016,1536,598016,1016096,865280,1018536,965632,1019448,1025024,1212416,1020256,1020440,1299456,1414144,17920,768000,1023360,4294967282
.long 1035168,1035264,4336,1017808,249856,3998720,3948800,1164544,1167360,749568,1016688,100992,57728,502400,58048,1536,606208,1016128,866304,1018544,972800,1019504,1025024,1327104,1020512,1020472,1313792,1428480,17920,770048,1023360,4294967282
.long 1035184,1035776,4336,1017816,251904,4031488,3948928,1164672,1169408,782336,1016816,151168,86400,703104,58080,1536,614400,1016160,867328,1018552,979968,1019560,1025024,1441792,1020768,1020496,1328128,1442816,17920,772096,1023360,4294967282
.long 1035200,1034240,4336,1017824,253952,4064256,3949056,1164800,1171456,686080,1016440,201344,115072,903808,86656,1536,622592,1016192,892928,1018784,987136,1019648,1025536,1556480,1021024,1020528,1457152,1342464,17920,774144,1023360,4294967282
.long 1035216,1034752,4336,1017832,256000,4097024,3949184,1164928,1173504,718848,1016568,251520,143744,1104512,86688,1536,630784,1016224,893952,1018792,994304,1019704,1025536,1671168,1021280,1020552,1471488,1356800,17920,776192,1023360,4294967282
.long 1035232,1035264,4336,1017840,258048,4129792,3949312,1165056,1175552,751616,1016696,301696,172416,1305216,86720,1536,638976,1016256,894976,1018800,1001472,1019760,1025536,1785856,1021536,1020584,1485824,1371136,17920,778240,1023360,4294967282
.long 1035248,1035776,4336,1017848,260096,4162560,3949440,1165184,1177600,784384,1016824,351872,201088,1505920,86752,1536,647168,1016288,896000,1018808,1008640,1019816,1025536,1900544,1021792,1020608,1500160,1385472,17920,780288,1023360,4294967282
.long 1033216,1032192,4352,1016832,0,2097152,2097152,1048576,1048576,524288,1015808,640,1536,100992,57984,1536,589824,1016064,864256,1018528,786432,1017856,1021952,1097728,1020000,1020416,1285120,1399808,22528,520192,1013760,4294967282
.long 1033232,1032704,4352,1016840,2048,2129920,2097280,1048704,1050624,557056,1015936,50816,30208,301696,58016,1536,598016,1016096,865280,1018536,815104,1018112,1022464,1212416,1020256,1020440,1299456,1414144,22528,522240,1013760,4294967282
.long 1033248,1033216,4352,1016848,4096,2162688,2097408,1048832,1052672,589824,1016064,100992,58880,502400,58048,1536,606208,1016128,866304,1018544,843776,1018368,1022976,1327104,1020512,1020472,1313792,1428480,22528,524288,1013760,4294967282
.long 1033264,1033728,4352,1016856,6144,2195456,2097536,1048960,1054720,622592,1016192,151168,87552,703104,58080,1536,614400,1016160,867328,1018552,872448,1018624,1023488,1441792,1020768,1020496,1328128,1442816,22528,526336,1013760,4294967282
.long 1033280,1032192,4352,1016864,8192,2228224,2097664,1049088,1056768,526336,1015816,201344,116224,903808,86656,1536,622592,1016192,892928,1018784,901120,1018880,1024000,1556480,1021024,1020528,1457152,1342464,22528,528384,1013760,4294967282
.long 1033296,1032704,4352,1016872,10240,2260992,2097792,1049216,1058816,559104,1015944,251520,144896,1104512,86688,1536,630784,1016224,893952,1018792,929792,1019136,1024512,1671168,1021280,1020552,1471488,1356800,22528,530432,1013760,4294967282
.long 1033312,1033216,4352,1016880,12288,2293760,2097920,1049344,1060864,591872,1016072,301696,173568,1305216,86720,1536,638976,1016256,894976,1018800,958464,1019392,1025024,1785856,1021536,1020584,1485824,1371136,22528,532480,1013760,4294967282
.long 1033328,1033728,4352,1016888,14336,2326528,2098048,1049472,1062912,624640,1016200,351872,202240,1505920,86752,1536,647168,1016288,896000,1018808,987136,1019648,1025536,1900544,1021792,1020608,1500160,1385472,22528,534528,1013760,4294967282
.long 1033344,1032192,4368,1016896,16384,2359296,2359296,1064960,1064960,528384,1015824,768,1664,903936,58112,1664,589824,1016064,868352,1018560,786432,1017856,1021952,1101824,1020008,1020528,1342464,1457152,23040,536576,1014400,4294967282
.long 1033360,1032704,4368,1016904,18432,2392064,2359424,1065088,1067008,561152,1015952,50944,30336,1104640,58144,1664,598016,1016096,869376,1018568,815104,1018112,1022464,1216512,1020264,1020552,1356800,1471488,23040,538624,1014400,4294967282
.long 1033376,1033216,4368,1016912,20480,2424832,2359552,1065216,1069056,593920,1016080,101120,59008,1305344,58176,1664,606208,1016128,870400,1018576,843776,1018368,1022976,1331200,1020520,1020584,1371136,1485824,23040,540672,1014400,4294967282
.long 1033392,1033728,4368,1016920,22528,2457600,2359680,1065344,1071104,626688,1016208,151296,87680,1506048,58208,1664,614400,1016160,871424,1018584,872448,1018624,1023488,1445888,1020776,1020608,1385472,1500160,23040,542720,1014400,4294967282
.long 1033408,1032192,4368,1016928,24576,2490368,2359808,1065472,1073152,530432,1015832,201472,116352,101120,86784,1664,622592,1016192,897024,1018816,901120,1018880,1024000,1560576,1021032,1020416,1399808,1285120,23040,544768,1014400,4294967282
.long 1033424,1032704,4368,1016936,26624,2523136,2359936,1065600,1075200,563200,1015960,251648,145024,301824,86816,1664,630784,1016224,898048,1018824,929792,1019136,1024512,1675264,1021288,1020440,1414144,1299456,23040,546816,1014400,4294967282
.long 1033440,1033216,4368,1016944,28672,2555904,2360064,1065728,1077248,595968,1016088,301824,173696,502528,86848,1664,638976,1016256,899072,1018832,958464,1019392,1025024,1789952,1021544,1020472,1428480,1313792,23040,548864,1014400,4294967282
.long 1033456,1033728,4368,1016952,30720,2588672,2360192,1065856,1079296,628736,1016216,352000,202368,703232,86880,1664,647168,1016288,900096,1018840,987136,1019648,1025536,1904640,1021800,1020496,1442816,1328128,23040,550912,1014400,4294967282
.long 1033472,1032192,4384,1016960,32768,2621440,2621440,1081344,1081344,532480,1015840,0,1792,100352,114688,1792,655360,1016320,901120,1018880,786432,1017856,1021952,1105920,1020016,1020928,1514496,1629184,23552,552960,1015040,4294967282
.long 1033488,1032704,4384,1016968,34816,2654208,2621568,1081472,1083392,565248,1015968,50176,30464,301056,114720,1792,663552,1016352,902144,1018888,815104,1018112,1022464,1220608,1020272,1020952,1528832,1643520,23552,555008,1015040,4294967282
.long 1033504,1033216,4384,1016976,36864,2686976,2621696,1081600,1085440,598016,1016096,100352,59136,501760,114752,1792,671744,1016384,903168,1018896,843776,1018368,1022976,1335296,1020528,1020984,1543168,1657856,23552,557056,1015040,4294967282
.long 1033520,1033728,4384,1016984,38912,2719744,2621824,1081728,1087488,630784,1016224,150528,87808,702464,114784,1792,679936,1016416,904192,1018904,872448,1018624,1023488,1449984,1020784,1021008,1557504,1672192,23552,559104,1015040,4294967282
.long 1033536,1032192,4384,1016992,40960,2752512,2621952,1081856,1089536,534528,1015848,200704,116480,903168,143360,1792,688128,1016448,929792,1019136,901120,1018880,1024000,1564672,1021040,1021040,1686528,1571840,23552,561152,1015040,4294967282
.long 1033552,1032704,4384,1017000,43008,2785280,2622080,1081984,1091584,567296,1015976,250880,145152,1103872,143392,1792,696320,1016480,930816,1019144,929792,1019136,1024512,1679360,1021296,1021064,1700864,1586176,23552,563200,1015040,4294967282
.long 1033568,1033216,4384,1017008,45056,2818048,2622208,1082112,1093632,600064,1016104,301056,173824,1304576,143424,1792,704512,1016512,931840,1019152,958464,1019392,1025024,1794048,1021552,1021096,1715200,1600512,23552,565248,1015040,4294967282
.long 1033584,1033728,4384,1017016,47104,2850816,2622336,1082240,1095680,632832,1016232,351232,202496,1505280,143456,1792,712704,1016544,932864,1019160,987136,1019648,1025536,1908736,1021808,1021120,1729536,1614848,23552,567296,1015040,4294967282
.long 1033600,1032192,4400,1017024,49152,2883584,2883584,1097728,1097728,536576,1015856,128,1920,903296,114816,1920,655360,1016320,905216,1018912,786432,1017856,1021952,1110016,1020024,1021040,1571840,1686528,24064,569344,1015680,4294967282
.long 1033616,1032704,4400,1017032,51200,2916352,2883712,1097856,1099776,569344,1015984,50304,30592,1104000,114848,1920,663552,1016352,906240,1018920,815104,1018112,1022464,1224704,1020280,1021064,1586176,1700864,24064,571392,1015680,4294967282
.long 1033632,1033216,4400,1017040,53248,2949120,2883840,1097984,1101824,602112,1016112,100480,59264,1304704,114880,1920,671744,1016384,907264,1018928,843776,1018368,1022976,1339392,1020536,1021096,1600512,1715200,24064,573440,1015680,4294967282
.long 1033648,1033728,4400,1017048,55296,2981888,2883968,1098112,1103872,634880,1016240,150656,87936,1505408,114912,1920,679936,1016416,908288,1018936,872448,1018624,1023488,1454080,1020792,1021120,1614848,1729536,24064,575488,1015680,4294967282
.long 1033664,1032192,4400,1017056,57344,3014656,2884096,1098240,1105920,538624,1015864,200832,116608,100480,143488,1920,688128,1016448,933888,1019168,901120,1018880,1024000,1568768,1021048,1020928,1629184,1514496,24064,577536,1015680,4294967282
.long 1033680,1032704,4400,1017064,59392,3047424,2884224,1098368,1107968,571392,1015992,251008,145280,301184,143520,1920,696320,1016480,934912,1019176,929792,1019136,1024512,1683456,1021304,1020952,1643520,1528832,24064,579584,1015680,4294967282
.long 1033696,1033216,4400,1017072,61440,3080192,2884352,1098496,1110016,604160,1016120,301184,173952,501888,143552,1920,704512,1016512,935936,1019184,958464,1019392,1025024,1798144,1021560,1020984,1657856,1543168,24064,581632,1015680,4294967282
.long 1033712,1033728,4400,1017080,63488,3112960,2884480,1098624,1112064,636928,1016248,351360,202624,702592,143584,1920,712704,1016544,936960,1019192,987136,1019648,1025536,1912832,1021816,1021008,1672192,1557504,24064,583680,1015680,4294967282
.long 1033728,1032192,4416,1017088,65536,3145728,3145728,1114112,1114112,540672,1015872,256,2048,256,114944,2048,655360,1016320,909312,1018944,786432,1017856,1021952,1114112,1020032,1020928,1507328,1622016,24576,585728,1016320,0
.long 1033744,1032704,4416,1017096,67584,3178496,3145856,1114240,1116160,573440,1016000,50432,30720,200960,114976,2048,663552,1016352,910336,1018952,815104,1018112,1022464,1228800,1020288,1020952,1521664,1636352,24576,587776,1016320,0
.long 1033760,1033216,4416,1017104,69632,3211264,3145984,1114368,1118208,606208,1016128,100608,59392,401664,115008,2048,671744,1016384,911360,1018960,843776,1018368,1022976,1343488,1020544,1020984,1536000,1650688,24576,589824,1016320,0
.long 1033776,1033728,4416,1017112,71680,3244032,3146112,1114496,1120256,638976,1016256,150784,88064,602368,115040,2048,679936,1016416,912384,1018968,872448,1018624,1023488,1458176,1020800,1021008,1550336,1665024,24576,591872,1016320,0
.long 1033792,1032192,4416,1017120,73728,3276800,3146240,1114624,1122304,542720,1015880,200960,116736,803072,143616,2048,688128,1016448,937984,1019200,901120,1018880,1024000,1572864,1021056,1021040,1679360,1564672,24576,593920,1016320,0
.long 1033808,1032704,4416,1017128,75776,3309568,3146368,1114752,1124352,575488,1016008,251136,145408,1003776,143648,2048,696320,1016480,939008,1019208,929792,1019136,1024512,1687552,1021312,1021064,1693696,1579008,24576,595968,1016320,0
.long 1033824,1033216,4416,1017136,77824,3342336,3146496,1114880,1126400,608256,1016136,301312,174080,1204480,143680,2048,704512,1016512,940032,1019216,958464,1019392,1025024,1802240,1021568,1021096,1708032,1593344,24576,598016,1016320,0
.long 1033840,1033728,4416,1017144,79872,3375104,3146624,1115008,1128448,641024,1016264,351488,202752,1405184,143712,2048,712704,1016544,941056,1019224,987136,1019648,1025536,1916928,1021824,1021120,1722368,1607680,24576,600064,1016320,0
.long 1033856,1032192,4432,1017152,81920,3407872,3407872,1130496,1130496,544768,1015888,384,2176,803200,115072,2176,655360,1016320,913408,1018976,786432,1017856,1021952,1118208,1020040,1021040,1564672,1679360,25088,602112,1016960,0
.long 1033872,1032704,4432,1017160,83968,3440640,3408000,1130624,1132544,577536,1016016,50560,30848,1003904,115104,2176,663552,1016352,914432,1018984,815104,1018112,1022464,1232896,1020296,1021064,1579008,1693696,25088,604160,1016960,0
.long 1033888,1033216,4432,1017168,86016,3473408,3408128,1130752,1134592,610304,1016144,100736,59520,1204608,115136,2176,671744,1016384,915456,1018992,843776,1018368,1022976,1347584,1020552,1021096,1593344,1708032,25088,606208,1016960,0
.long 1033904,1033728,4432,1017176,88064,3506176,3408256,1130880,1136640,643072,1016272,150912,88192,1405312,115168,2176,679936,1016416,916480,1019000,872448,1018624,1023488,1462272,1020808,1021120,1607680,1722368,25088,608256,1016960,0
.long 1033920,1032192,4432,1017184,90112,3538944,3408384,1131008,1138688,546816,1015896,201088,116864,384,143744,2176,688128,1016448,942080,1019232,901120,1018880,1024000,1576960,1021064,1020928,1622016,1507328,25088,610304,1016960,0
.long 1033936,1032704,4432,1017192,92160,3571712,3408512,1131136,1140736,579584,1016024,251264,145536,201088,143776,2176,696320,1016480,943104,1019240,929792,1019136,1024512,1691648,1021320,1020952,1636352,1521664,25088,612352,1016960,0
.long 1033952,1033216,4432,1017200,94208,3604480,3408640,1131264,1142784,612352,1016152,301440,174208,401792,143808,2176,704512,1016512,944128,1019248,958464,1019392,1025024,1806336,1021576,1020984,1650688,1536000,25088,614400,1016960,0
.long 1033968,1033728,4432,1017208,96256,3637248,3408768,1131392,1144832,645120,1016280,351616,202880,602496,143840,2176,712704,1016544,945152,1019256,987136,1019648,1025536,1921024,1021832,1021008,1665024,1550336,25088,616448,1016960,0
.long 1033984,1032192,4448,1017216,98304,3670016,3670016,1146880,1146880,548864,1015904,512,2304,100864,115200,2304,655360,1016320,917504,1019008,786432,1017856,1021952,1122304,1020048,1020928,1514496,1629184,25600,618496,1017600,4294967282
.long 1034000,1032704,4448,1017224,100352,3702784,3670144,1147008,1148928,581632,1016032,50688,30976,301568,115232,2304,663552,1016352,918528,1019016,815104,1018112,1022464,1236992,1020304,1020952,1528832,1643520,25600,620544,1017600,4294967282
.long 1034016,1033216,4448,1017232,102400,3735552,3670272,1147136,1150976,614400,1016160,100864,59648,502272,115264,2304,671744,1016384,919552,1019024,843776,1018368,1022976,1351680,1020560,1020984,1543168,1657856,25600,622592,1017600,4294967282
.long 1034032,1033728,4448,1017240,104448,3768320,3670400,1147264,1153024,647168,1016288,151040,88320,702976,115296,2304,679936,1016416,920576,1019032,872448,1018624,1023488,1466368,1020816,1021008,1557504,1672192,25600,624640,1017600,4294967282
.long 1034048,1032192,4448,1017248,106496,3801088,3670528,1147392,1155072,550912,1015912,201216,116992,903680,143872,2304,688128,1016448,946176,1019264,901120,1018880,1024000,1581056,1021072,1021040,1686528,1571840,25600,626688,1017600,4294967282
.long 1034064,1032704,4448,1017256,108544,3833856,3670656,1147520,1157120,583680,1016040,251392,145664,1104384,143904,2304,696320,1016480,947200,1019272,929792,1019136,1024512,1695744,1021328,1021064,1700864,1586176,25600,628736,1017600,4294967282
.long 1034080,1033216,4448,1017264,110592,3866624,3670784,1147648,1159168,616448,1016168,301568,174336,1305088,143936,2304,704512,1016512,948224,1019280,958464,1019392,1025024,1810432,1021584,1021096,1715200,1600512,25600,630784,1017600,4294967282
.long 1034096,1033728,4448,1017272,112640,3899392,3670912,1147776,1161216,649216,1016296,351744,203008,1505792,143968,2304,712704,1016544,949248,1019288,987136,1019648,1025536,1925120,1021840,1021120,1729536,1614848,25600,632832,1017600,4294967282
.long 1034112,1032192,4464,1017280,114688,3932160,3932160,1163264,1163264,552960,1015920,640,2432,903808,115328,2432,655360,1016320,921600,1019040,786432,1017856,1021952,1126400,1020056,1021040,1571840,1686528,26112,634880,1018240,4294967282
.long 1034128,1032704,4464,1017288,116736,3964928,3932288,1163392,1165312,585728,1016048,50816,31104,1104512,115360,2432,663552,1016352,922624,1019048,815104,1018112,1022464,1241088,1020312,1021064,1586176,1700864,26112,636928,1018240,4294967282
.long 1034144,1033216,4464,1017296,118784,3997696,3932416,1163520,1167360,618496,1016176,100992,59776,1305216,115392,2432,671744,1016384,923648,1019056,843776,1018368,1022976,1355776,1020568,1021096,1600512,1715200,26112,638976,1018240,4294967282
.long 1034160,1033728,4464,1017304,120832,4030464,3932544,1163648,1169408,651264,1016304,151168,88448,1505920,115424,2432,679936,1016416,924672,1019064,872448,1018624,1023488,1470464,1020824,1021120,1614848,1729536,26112,641024,1018240,4294967282
.long 1034176,1032192,4464,1017312,122880,4063232,3932672,1163776,1171456,555008,1015928,201344,117120,100992,144000,2432,688128,1016448,950272,1019296,901120,1018880,1024000,1585152,1021080,1020928,1629184,1514496,26112,643072,1018240,4294967282
.long 1034192,1032704,4464,1017320,124928,4096000,3932800,1163904,1173504,587776,1016056,251520,145792,301696,144032,2432,696320,1016480,951296,1019304,929792,1019136,1024512,1699840,1021336,1020952,1643520,1528832,26112,645120,1018240,4294967282
.long 1034208,1033216,4464,1017328,126976,4128768,3932928,1164032,1175552,620544,1016184,301696,174464,502400,144064,2432,704512,1016512,952320,1019312,958464,1019392,1025024,1814528,1021592,1020984,1657856,1543168,26112,647168,1018240,4294967282
.long 1034224,1033728,4464,1017336,129024,4161536,3933056,1164160,1177600,653312,1016312,351872,203136,703104,144096,2432,712704,1016544,953344,1019320,987136,1019648,1025536,1929216,1021848,1021008,1672192,1557504,26112,649216,1018240,4294967282
.long 1035264,1034240,4480,1017344,131072,2098176,2113536,1049600,1048576,655360,1016320,768,2560,768,115456,2560,655360,1016320,925696,1019072,786432,1017856,1021952,1130496,1020064,1020928,1507328,1622016,26624,651264,1018880,0
.long 1035280,1034752,4480,1017352,133120,2130944,2113664,1049728,1050624,688128,1016448,50944,31232,201472,115488,2560,663552,1016352,926720,1019080,815104,1018112,1022464,1245184,1020320,1020952,1521664,1636352,26624,653312,1018880,0
.long 1035296,1035264,4480,1017360,135168,2163712,2113792,1049856,1052672,720896,1016576,101120,59904,402176,115520,2560,671744,1016384,927744,1019088,843776,1018368,1022976,1359872,1020576,1020984,1536000,1650688,26624,655360,1018880,0
.long 1035312,1035776,4480,1017368,137216,2196480,2113920,1049984,1054720,753664,1016704,151296,88576,602880,115552,2560,679936,1016416,928768,1019096,872448,1018624,1023488,1474560,1020832,1021008,1550336,1665024,26624,657408,1018880,0
.long 1035328,1034240,4480,1017376,139264,2229248,2114048,1050112,1056768,657408,1016328,201472,117248,803584,144128,2560,688128,1016448,954368,1019328,901120,1018880,1024000,1589248,1021088,1021040,1679360,1564672,26624,659456,1018880,0
.long 1035344,1034752,4480,1017384,141312,2262016,2114176,1050240,1058816,690176,1016456,251648,145920,1004288,144160,2560,696320,1016480,955392,1019336,929792,1019136,1024512,1703936,1021344,1021064,1693696,1579008,26624,661504,1018880,0
.long 1035360,1035264,4480,1017392,143360,2294784,2114304,1050368,1060864,722944,1016584,301824,174592,1204992,144192,2560,704512,1016512,956416,1019344,958464,1019392,1025024,1818624,1021600,1021096,1708032,1593344,26624,663552,1018880,0
.long 1035376,1035776,4480,1017400,145408,2327552,2114432,1050496,1062912,755712,1016712,352000,203264,1405696,144224,2560,712704,1016544,957440,1019352,987136,1019648,1025536,1933312,1021856,1021120,1722368,1607680,26624,665600,1018880,0
.long 1035392,1034240,4496,1017408,147456,2360320,2375680,1065984,1064960,659456,1016336,0,2688,903168,172032,2688,720896,1016576,958464,1019392,786432,1017856,1021952,1134592,1020072,1021552,1801216,1915904,27136,667648,1019520,4294967282
.long 1035408,1034752,4496,1017416,149504,2393088,2375808,1066112,1067008,692224,1016464,50176,31360,1103872,172064,2688,729088,1016608,959488,1019400,815104,1018112,1022464,1249280,1020328,1021576,1815552,1930240,27136,669696,1019520,4294967282
.long 1035424,1035264,4496,1017424,151552,2425856,2375936,1066240,1069056,724992,1016592,100352,60032,1304576,172096,2688,737280,1016640,960512,1019408,843776,1018368,1022976,1363968,1020584,1021608,1829888,1944576,27136,671744,1019520,4294967282
.long 1035440,1035776,4496,1017432,153600,2458624,2376064,1066368,1071104,757760,1016720,150528,88704,1505280,172128,2688,745472,1016672,961536,1019416,872448,1018624,1023488,1478656,1020840,1021632,1844224,1958912,27136,673792,1019520,4294967282
.long 1035456,1034240,4496,1017440,155648,2491392,2376192,1066496,1073152,661504,1016344,200704,117376,100352,200704,2688,753664,1016704,987136,1019648,901120,1018880,1024000,1593344,1021096,1021440,1858560,1743872,27136,675840,1019520,4294967282
.long 1035472,1034752,4496,1017448,157696,2524160,2376320,1066624,1075200,694272,1016472,250880,146048,301056,200736,2688,761856,1016736,988160,1019656,929792,1019136,1024512,1708032,1021352,1021464,1872896,1758208,27136,677888,1019520,4294967282
.long 1035488,1035264,4496,1017456,159744,2556928,2376448,1066752,1077248,727040,1016600,301056,174720,501760,200768,2688,770048,1016768,989184,1019664,958464,1019392,1025024,1822720,1021608,1021496,1887232,1772544,27136,679936,1019520,4294967282
.long 1035504,1035776,4496,1017464,161792,2589696,2376576,1066880,1079296,759808,1016728,351232,203392,702464,200800,2688,778240,1016800,990208,1019672,987136,1019648,1025536,1937408,1021864,1021520,1901568,1786880,27136,681984,1019520,4294967282
.long 1035520,1034240,4512,1017472,163840,2622464,2637824,1082368,1081344,663552,1016352,128,2816,128,172160,2816,720896,1016576,962560,1019424,786432,1017856,1021952,1138688,1020080,1021440,1736704,1851392,27648,684032,1020160,0
.long 1035536,1034752,4512,1017480,165888,2655232,2637952,1082496,1083392,696320,1016480,50304,31488,200832,172192,2816,729088,1016608,963584,1019432,815104,1018112,1022464,1253376,1020336,1021464,1751040,1865728,27648,686080,1020160,0
.long 1035552,1035264,4512,1017488,167936,2688000,2638080,1082624,1085440,729088,1016608,100480,60160,401536,172224,2816,737280,1016640,964608,1019440,843776,1018368,1022976,1368064,1020592,1021496,1765376,1880064,27648,688128,1020160,0
.long 1035568,1035776,4512,1017496,169984,2720768,2638208,1082752,1087488,761856,1016736,150656,88832,602240,172256,2816,745472,1016672,965632,1019448,872448,1018624,1023488,1482752,1020848,1021520,1779712,1894400,27648,690176,1020160,0
.long 1035584,1034240,4512,1017504,172032,2753536,2638336,1082880,1089536,665600,1016360,200832,117504,802944,200832,2816,753664,1016704,991232,1019680,901120,1018880,1024000,1597440,1021104,1021552,1908736,1794048,27648,692224,1020160,0
.long 1035600,1034752,4512,1017512,174080,2786304,2638464,1083008,1091584,698368,1016488,251008,146176,1003648,200864,2816,761856,1016736,992256,1019688,929792,1019136,1024512,1712128,1021360,1021576,1923072,1808384,27648,694272,1020160,0
.long 1035616,1035264,4512,1017520,176128,2819072,2638592,1083136,1093632,731136,1016616,301184,174848,1204352,200896,2816,770048,1016768,993280,1019696,958464,1019392,1025024,1826816,1021616,1021608,1937408,1822720,27648,696320,1020160,0
.long 1035632,1035776,4512,1017528,178176,2851840,2638720,1083264,1095680,763904,1016744,351360,203520,1405056,200928,2816,778240,1016800,994304,1019704,987136,1019648,1025536,1941504,1021872,1021632,1951744,1837056,27648,698368,1020160,0
.long 1035648,1034240,4528,1017536,180224,2884608,2899968,1098752,1097728,667648,1016368,256,2944,803072,172288,2944,720896,1016576,966656,1019456,786432,1017856,1021952,1142784,1020088,1021552,1794048,1908736,28160,700416,1020800,0
.long 1035664,1034752,4528,1017544,182272,2917376,2900096,1098880,1099776,700416,1016496,50432,31616,1003776,172320,2944,729088,1016608,967680,1019464,815104,1018112,1022464,1257472,1020344,1021576,1808384,1923072,28160,702464,1020800,0
.long 1035680,1035264,4528,1017552,184320,2950144,2900224,1099008,1101824,733184,1016624,100608,60288,1204480,172352,2944,737280,1016640,968704,1019472,843776,1018368,1022976,1372160,1020600,1021608,1822720,1937408,28160,704512,1020800,0
.long 1035696,1035776,4528,1017560,186368,2982912,2900352,1099136,1103872,765952,1016752,150784,88960,1405184,172384,2944,745472,1016672,969728,1019480,872448,1018624,1023488,1486848,1020856,1021632,1837056,1951744,28160,706560,1020800,0
.long 1035712,1034240,4528,1017568,188416,3015680,2900480,1099264,1105920,669696,1016376,200960,117632,256,200960,2944,753664,1016704,995328,1019712,901120,1018880,1024000,1601536,1021112,1021440,1851392,1736704,28160,708608,1020800,0
.long 1035728,1034752,4528,1017576,190464,3048448,2900608,1099392,1107968,702464,1016504,251136,146304,200960,200992,2944,761856,1016736,996352,1019720,929792,1019136,1024512,1716224,1021368,1021464,1865728,1751040,28160,710656,1020800,0
.long 1035744,1035264,4528,1017584,192512,3081216,2900736,1099520,1110016,735232,1016632,301312,174976,401664,201024,2944,770048,1016768,997376,1019728,958464,1019392,1025024,1830912,1021624,1021496,1880064,1765376,28160,712704,1020800,0
.long 1035760,1035776,4528,1017592,194560,3113984,2900864,1099648,1112064,768000,1016760,351488,203648,602368,201056,2944,778240,1016800,998400,1019736,987136,1019648,1025536,1945600,1021880,1021520,1894400,1779712,28160,714752,1020800,0
.long 1035776,1034240,4544,1017600,196608,3146752,3162112,1115136,1114112,671744,1016384,384,3072,100736,172416,3072,720896,1016576,970752,1019488,786432,1017856,1021952,1146880,1020096,1021440,1743872,1858560,28672,716800,1021440,4294967282
.long 1035792,1034752,4544,1017608,198656,3179520,3162240,1115264,1116160,704512,1016512,50560,31744,301440,172448,3072,729088,1016608,971776,1019496,815104,1018112,1022464,1261568,1020352,1021464,1758208,1872896,28672,718848,1021440,4294967282
.long 1035808,1035264,4544,1017616,200704,3212288,3162368,1115392,1118208,737280,1016640,100736,60416,502144,172480,3072,737280,1016640,972800,1019504,843776,1018368,1022976,1376256,1020608,1021496,1772544,1887232,28672,720896,1021440,4294967282
.long 1035824,1035776,4544,1017624,202752,3245056,3162496,1115520,1120256,770048,1016768,150912,89088,702848,172512,3072,745472,1016672,973824,1019512,872448,1018624,1023488,1490944,1020864,1021520,1786880,1901568,28672,722944,1021440,4294967282
.long 1035840,1034240,4544,1017632,204800,3277824,3162624,1115648,1122304,673792,1016392,201088,117760,903552,201088,3072,753664,1016704,999424,1019744,901120,1018880,1024000,1605632,1021120,1021552,1915904,1801216,28672,724992,1021440,4294967282
.long 1035856,1034752,4544,1017640,206848,3310592,3162752,1115776,1124352,706560,1016520,251264,146432,1104256,201120,3072,761856,1016736,1000448,1019752,929792,1019136,1024512,1720320,1021376,1021576,1930240,1815552,28672,727040,1021440,4294967282
.long 1035872,1035264,4544,1017648,208896,3343360,3162880,1115904,1126400,739328,1016648,301440,175104,1304960,201152,3072,770048,1016768,1001472,1019760,958464,1019392,1025024,1835008,1021632,1021608,1944576,1829888,28672,729088,1021440,4294967282
.long 1035888,1035776,4544,1017656,210944,3376128,3163008,1116032,1128448,772096,1016776,351616,203776,1505664,201184,3072,778240,1016800,1002496,1019768,987136,1019648,1025536,1949696,1021888,1021632,1958912,1844224,28672,731136,1021440,4294967282
.long 1035904,1034240,4560,1017664,212992,3408896,3424256,1131520,1130496,675840,1016400,512,3200,903680,172544,3200,720896,1016576,974848,1019520,786432,1017856,1021952,1150976,1020104,1021552,1801216,1915904,29184,733184,1022080,4294967282
.long 1035920,1034752,4560,1017672,215040,3441664,3424384,1131648,1132544,708608,1016528,50688,31872,1104384,172576,3200,729088,1016608,975872,1019528,815104,1018112,1022464,1265664,1020360,1021576,1815552,1930240,29184,735232,1022080,4294967282
.long 1035936,1035264,4560,1017680,217088,3474432,3424512,1131776,1134592,741376,1016656,100864,60544,1305088,172608,3200,737280,1016640,976896,1019536,843776,1018368,1022976,1380352,1020616,1021608,1829888,1944576,29184,737280,1022080,4294967282
.long 1035952,1035776,4560,1017688,219136,3507200,3424640,1131904,1136640,774144,1016784,151040,89216,1505792,172640,3200,745472,1016672,977920,1019544,872448,1018624,1023488,1495040,1020872,1021632,1844224,1958912,29184,739328,1022080,4294967282
.long 1035968,1034240,4560,1017696,221184,3539968,3424768,1132032,1138688,677888,1016408,201216,117888,100864,201216,3200,753664,1016704,1003520,1019776,901120,1018880,1024000,1609728,1021128,1021440,1858560,1743872,29184,741376,1022080,4294967282
.long 1035984,1034752,4560,1017704,223232,3572736,3424896,1132160,1140736,710656,1016536,251392,146560,301568,201248,3200,761856,1016736,1004544,1019784,929792,1019136,1024512,1724416,1021384,1021464,1872896,1758208,29184,743424,1022080,4294967282
.long 1036000,1035264,4560,1017712,225280,3605504,3425024,1132288,1142784,743424,1016664,301568,175232,502272,201280,3200,770048,1016768,1005568,1019792,958464,1019392,1025024,1839104,1021640,1021496,1887232,1772544,29184,745472,1022080,4294967282
.long 1036016,1035776,4560,1017720,227328,3638272,3425152,1132416,1144832,776192,1016792,351744,203904,702976,201312,3200,778240,1016800,1006592,1019800,987136,1019648,1025536,1953792,1021896,1021520,1901568,1786880,29184,747520,1022080,4294967282
.long 1036032,1034240,4576,1017728,229376,3671040,3686400,1147904,1146880,679936,1016416,640,3328,640,172672,3328,720896,1016576,978944,1019552,786432,1017856,1021952,1155072,1020112,1021440,1736704,1851392,29696,749568,1022720,0
.long 1036048,1034752,4576,1017736,231424,3703808,3686528,1148032,1148928,712704,1016544,50816,32000,201344,172704,3328,729088,1016608,979968,1019560,815104,1018112,1022464,1269760,1020368,1021464,1751040,1865728,29696,751616,1022720,0
.long 1036064,1035264,4576,1017744,233472,3736576,3686656,1148160,1150976,745472,1016672,100992,60672,402048,172736,3328,737280,1016640,980992,1019568,843776,1018368,1022976,1384448,1020624,1021496,1765376,1880064,29696,753664,1022720,0
.long 1036080,1035776,4576,1017752,235520,3769344,3686784,1148288,1153024,778240,1016800,151168,89344,602752,172768,3328,745472,1016672,982016,1019576,872448,1018624,1023488,1499136,1020880,1021520,1779712,1894400,29696,755712,1022720,0
.long 1036096,1034240,4576,1017760,237568,3802112,3686912,1148416,1155072,681984,1016424,201344,118016,803456,201344,3328,753664,1016704,1007616,1019808,901120,1018880,1024000,1613824,1021136,1021552,1908736,1794048,29696,757760,1022720,0
.long 1036112,1034752,4576,1017768,239616,3834880,3687040,1148544,1157120,714752,1016552,251520,146688,1004160,201376,3328,761856,1016736,1008640,1019816,929792,1019136,1024512,1728512,1021392,1021576,1923072,1808384,29696,759808,1022720,0
.long 1036128,1035264,4576,1017776,241664,3867648,3687168,1148672,1159168,747520,1016680,301696,175360,1204864,201408,3328,770048,1016768,1009664,1019824,958464,1019392,1025024,1843200,1021648,1021608,1937408,1822720,29696,761856,1022720,0
.long 1036144,1035776,4576,1017784,243712,3900416,3687296,1148800,1161216,780288,1016808,351872,204032,1405568,201440,3328,778240,1016800,1010688,1019832,987136,1019648,1025536,1957888,1021904,1021632,1951744,1837056,29696,763904,1022720,0
.long 1036160,1034240,4592,1017792,245760,3933184,3948544,1164288,1163264,684032,1016432,768,3456,803584,172800,3456,720896,1016576,983040,1019584,786432,1017856,1021952,1159168,1020120,1021552,1794048,1908736,30208,765952,1023360,0
.long 1036176,1034752,4592,1017800,247808,3965952,3948672,1164416,1165312,716800,1016560,50944,32128,1004288,172832,3456,729088,1016608,984064,1019592,815104,1018112,1022464,1273856,1020376,1021576,1808384,1923072,30208,768000,1023360,0
.long 1036192,1035264,4592,1017808,249856,3998720,3948800,1164544,1167360,749568,1016688,101120,60800,1204992,172864,3456,737280,1016640,985088,1019600,843776,1018368,1022976,1388544,1020632,1021608,1822720,1937408,30208,770048,1023360,0
.long 1036208,1035776,4592,1017816,251904,4031488,3948928,1164672,1169408,782336,1016816,151296,89472,1405696,172896,3456,745472,1016672,986112,1019608,872448,1018624,1023488,1503232,1020888,1021632,1837056,1951744,30208,772096,1023360,0
.long 1036224,1034240,4592,1017824,253952,4064256,3949056,1164800,1171456,686080,1016440,201472,118144,768,201472,3456,753664,1016704,1011712,1019840,901120,1018880,1024000,1617920,1021144,1021440,1851392,1736704,30208,774144,1023360,0
.long 1036240,1034752,4592,1017832,256000,4097024,3949184,1164928,1173504,718848,1016568,251648,146816,201472,201504,3456,761856,1016736,1012736,1019848,929792,1019136,1024512,1732608,1021400,1021464,1865728,1751040,30208,776192,1023360,0
.long 1036256,1035264,4592,1017840,258048,4129792,3949312,1165056,1175552,751616,1016696,301824,175488,402176,201536,3456,770048,1016768,1013760,1019856,958464,1019392,1025024,1847296,1021656,1021496,1880064,1765376,30208,778240,1023360,0
.long 1036272,1035776,4592,1017848,260096,4162560,3949440,1165184,1177600,784384,1016824,352000,204160,602880,201568,3456,778240,1016800,1014784,1019864,987136,1019648,1025536,1961984,1021912,1021520,1894400,1779712,30208,780288,1023360,0
.size L_table, 32768
.section .rodata,"a"
.p2align 6
.amdhsa_kernel sequential_preLN__linear_kernel_hedgehog__dense_activation_mish__prompt_kernel
  .amdhsa_next_free_vgpr 256
  .amdhsa_next_free_sgpr 102
  .amdhsa_accum_offset 256
  .amdhsa_group_segment_fixed_size 0
  .amdhsa_kernarg_size 88
  .amdhsa_user_sgpr_count 2
  .amdhsa_user_sgpr_kernarg_segment_ptr 1
  .amdhsa_system_sgpr_workgroup_id_x 1
.end_amdhsa_kernel
```
